```python
import torch

def _softmax(x, axis=-1):
    return torch.softmax(x, dim=axis)
def _gelu(x):
    return torch.nn.functional.gelu(x, approximate="tanh")
def _silu(x):
    return torch.nn.functional.silu(x)
def _sigmoid(x):
    return torch.sigmoid(x)
def _layernorm(x, axis=-1, eps=1e-5):
    m = x.mean(dim=axis, keepdim=True)
    v = x.var(dim=axis, keepdim=True, unbiased=False)
    return (x - m) / torch.sqrt(v + eps)
def _scatter_add(tgt, idx, src, axis=0):
    return tgt.clone().index_add_(axis, idx, src)
def _segment_sum(src, seg, n):
    out = torch.zeros((n,) + src.shape[1:], dtype=src.dtype)
    return out.index_add_(0, seg, src)
def _pad(x, pw):
    flat = tuple(v for pair in reversed(pw) for v in pair)
    return torch.nn.functional.pad(x, flat)

kernel_name = 'recurrent_scan__compressed_kv_cla__geglu_ffn__decode'

def setup_inputs():

    _w = (lambda a: (lambda t: t.to(torch.bfloat16) if t.is_floating_point() else t)(torch.as_tensor(a)))
    def _A_setup():
        B, H, Sq, Sk, D, M = 1, 32, 1, 16384, 128, 512
        Dc = 4 * D
        return {
            "x": _w((lambda *s: torch.randn(*s, dtype=torch.bfloat16) * 0.05)(B, Sq, M)),
            "c_kv": _w((lambda *s: torch.randn(*s, dtype=torch.bfloat16) * 0.8)(B, Sk, Dc)),
            "w_q": _w((lambda *s: torch.randn(*s, dtype=torch.bfloat16) * 1.6)(M, H, D) * (M ** -0.5)),
            "w_uk": _w((lambda *s: torch.randn(*s, dtype=torch.bfloat16) * 1.6)(Dc, H, D) * (Dc ** -0.5)),
            "w_uv": _w((lambda *s: torch.randn(*s, dtype=torch.bfloat16) * 0.8)(Dc, H, D) * (Dc ** -0.5)),
            "w_o": _w((lambda *s: torch.randn(*s, dtype=torch.bfloat16) * 0.8)(H, D, M) * ((H * D) ** -0.5)),
        }
    _A_in = _A_setup()

    def _B_setup():
        B, S, D, F = 1, 1, 512, 1792
        return {
            "x": _w((lambda *s: torch.randn(*s, dtype=torch.bfloat16) * 0.05)(B, S, D)),
            "w_gate": _w((lambda *s: torch.randn(*s, dtype=torch.bfloat16) * 0.2)(D, F)),
            "w_up": _w((lambda *s: torch.randn(*s, dtype=torch.bfloat16) * 0.2)(D, F)),
            "w_down": _w((lambda *s: torch.randn(*s, dtype=torch.bfloat16) * 0.2)(F, D)),
        }
    _B_in = _B_setup()

    return {
        "A_x": _A_in["x"],
        "A_c_kv": _A_in["c_kv"],
        "A_w_q": _A_in["w_q"],
        "A_w_uk": _A_in["w_uk"],
        "A_w_uv": _A_in["w_uv"],
        "A_w_o": _A_in["w_o"],
        "B_x": _B_in["x"],
        "B_w_gate": _B_in["w_gate"],
        "B_w_up": _B_in["w_up"],
        "B_w_down": _B_in["w_down"],
    }

def reference(A_x, A_c_kv, A_w_q, A_w_uk, A_w_uv, A_w_o, B_x, B_w_gate, B_w_up, B_w_down):
    def _A_ref(x, c_kv, w_q, w_uk, w_uv, w_o):
        B, Sq, M = x.shape[0], x.shape[1], x.shape[2]
        Sk = c_kv.shape[1]
        H, D = w_q.shape[1], w_q.shape[2]
        q = torch.einsum("bqm,mhd->bhqd", x, w_q)
        k = torch.einsum("bkc,chd->bhkd", c_kv, w_uk)
        v = torch.einsum("bkc,chd->bhkd", c_kv, w_uv)
        scores = torch.einsum("bhqd,bhkd->bhqk", q, k) * (D ** -0.5)
        off = Sk - Sq
        qi = torch.arange(Sq)[:, None]
        kj = torch.arange(Sk)[None, :]
        cmask = kj <= (qi + off)
        scores = torch.where(cmask[None, None], scores, -1e9)
        p = _softmax(scores, axis=-1)
        ctx = torch.einsum("bhqk,bhkd->bhqd", p, v)
        return torch.einsum("bhqd,hdm->bqm", ctx, w_o)

    def _B_ref(x, w_gate, w_up, w_down):
        return (_gelu(x @ w_gate) * (x @ w_up)) @ w_down

    x = A_x
    xn = _layernorm(x, axis=-1)
    s = _A_ref(xn, A_c_kv, A_w_q, A_w_uk, A_w_uv, A_w_o)
    g = _silu(_B_ref(xn, B_w_gate, B_w_up, B_w_down))
    return x + s * g
```

```asm
; @launch grid=(256,1,1) block=(512,1,1) lds=161280
.amdgcn_target "amdgcn-amd-amdhsa--gfx950"
.text
.globl recurrent_scan__compressed_kv_cla__geglu_ffn__decode_kernel
.p2align 8
.type recurrent_scan__compressed_kv_cla__geglu_ffn__decode_kernel,@function
recurrent_scan__compressed_kv_cla__geglu_ffn__decode_kernel:
    s_load_dwordx16 s[4:19], s[0:1], 0
    s_load_dwordx8 s[20:27], s[0:1], 64
    s_load_dwordx2 s[28:29], s[0:1], 96
    s_getpc_b64 s[56:57]
L_pc:
    v_subrev_u32 v8, 384, v0
    v_lshlrev_b32 v8, 7, v8
    v_cmp_gt_u32 vcc, L_end-L_pc, v8
    s_and_saveexec_b64 s[60:61], vcc
    s_cbranch_execz L_npf
    s_cmp_ge_u32 s2, 256
    s_cbranch_scc1 L_npf
    global_load_dword v9, v8, s[56:57]
L_npf:
    s_mov_b64 exec, s[60:61]
    s_cmp_ge_u32 s2, 256
    s_cbranch_scc1 L_end
    v_lshrrev_b32 v1, 6, v0
    v_and_b32 v0, 63, v0
    v_readfirstlane_b32 s3, v1
    v_lshlrev_b32 v1, 4, v0
    v_mov_b32 v19, 0
    v_mov_b32 v60, 0
    v_mov_b32 v61, 0
    v_and_b32 v2, 15, v0
    v_lshrrev_b32 v3, 4, v0
    v_and_b32 v4, 7, v0
    v_lshrrev_b32 v5, 3, v0
    s_and_b32 s30, s2, 7
    s_lshr_b32 s31, s2, 3
    s_lshr_b32 s32, s31, 4
    s_and_b32 s33, s31, 7
    s_lshr_b32 s41, s31, 3
    s_and_b32 s42, s41, 1
    s_lshl_b32 s34, s32, 4
    s_lshl_b32 s43, s30, 1
    s_add_u32 s34, s34, s43
    s_add_u32 s34, s34, s42
    s_lshl_b32 s35, s30, 4
    s_and_b32 s42, s31, 15
    s_add_u32 s35, s35, s42
    s_lshl_b32 s36, s41, 3
    s_add_u32 s36, s36, s30
    v_lshlrev_b32 v64, 4, v5
    s_lshl_b32 s41, s33, 7
    v_add_u32 v64, s41, v64
    v_lshlrev_b32 v65, 16, v5
    v_lshl_add_u32 v65, v4, 4, v65
    s_lshl_b32 s41, s33, 19
    s_lshl_b32 s42, s34, 8
    s_add_u32 s43, s41, s42
    s_lshl_b32 s42, s3, 7
    s_add_u32 s41, s43, s42
    s_mov_b32 s54, 4194304
    s_mov_b32 s55, 0x00020000
    s_cmp_ge_u32 s3, 2
    s_waitcnt lgkmcnt(0)
    s_cbranch_scc1 L_not01
    s_mov_b64 s[52:53], s[8:9]
    s_setprio 3
    global_load_dwordx4 v[8:11], v1, s[4:5]
    global_load_dwordx4 v[12:15], v64, s[4:5]
    buffer_load_dwordx4 v[32:35], v65, s[52:55], s41 offen nt
    s_add_u32 s41, s41, 8192
    buffer_load_dwordx4 v[36:39], v65, s[52:55], s41 offen nt
    s_add_u32 s41, s41, 8192
    buffer_load_dwordx4 v[40:43], v65, s[52:55], s41 offen nt
    s_add_u32 s41, s41, 8192
    buffer_load_dwordx4 v[44:47], v65, s[52:55], s41 offen nt
    s_add_u32 s41, s41, 8192
    buffer_load_dwordx4 v[48:51], v65, s[52:55], s41 offen nt
    s_add_u32 s41, s41, 8192
    buffer_load_dwordx4 v[52:55], v65, s[52:55], s41 offen nt
    s_add_u32 s41, s41, 8192
    buffer_load_dwordx4 v[56:59], v65, s[52:55], s41 offen nt
    s_add_u32 s41, s41, 8192
    buffer_load_dwordx4 v[60:63], v65, s[52:55], s41 offen nt
    s_load_dword s37, s[28:29], 0
    s_mov_b32 s38, 0x05040100
    s_mov_b32 s39, 0x07060302
    s_mov_b32 s47, 0xffff0000
    s_mov_b32 s68, 0xffffff00
    s_mov_b32 s69, 0x00010001
    s_mov_b32 s16, 0x8000
    s_mul_i32 s30, s34, 266240
    s_mul_i32 s31, s36, 266240
    s_mul_i32 s17, s32, 4259840
    s_mov_b32 s48, s28
    s_mov_b32 s49, s29
    s_mov_b32 s50, 268435456
    s_mov_b32 s51, 0x00020000
    s_add_u32 s44, s30, 65536
    s_lshl_b32 s41, s33, 9
    s_add_u32 s41, s41, s44
    s_lshl_b32 s42, s3, 8
    s_add_u32 s41, s41, s42
    v_lshl_add_u32 v29, v0, 2, s41
    s_waitcnt vmcnt(9)
    v_lshlrev_b32 v64, 16, v8
    v_and_b32 v65, s47, v8
    v_lshlrev_b32 v66, 16, v9
    v_and_b32 v67, s47, v9
    v_lshlrev_b32 v68, 16, v10
    v_and_b32 v69, s47, v10
    v_lshlrev_b32 v70, 16, v11
    v_and_b32 v71, s47, v11
    v_pk_add_f32 v[72:73], v[64:65], v[66:67]
    v_pk_add_f32 v[74:75], v[68:69], v[70:71]
    v_pk_add_f32 v[72:73], v[72:73], v[74:75]
    v_add_f32 v72, v72, v73
    s_nop 1
    v_add_f32_dpp v72, v72, v72 quad_perm:[1,0,3,2] row_mask:0xf bank_mask:0xf
    s_nop 1
    v_add_f32_dpp v72, v72, v72 quad_perm:[2,3,0,1] row_mask:0xf bank_mask:0xf
    s_nop 1
    v_add_f32_dpp v72, v72, v72 row_half_mirror row_mask:0xf bank_mask:0xf
    s_nop 1
    v_add_f32_dpp v72, v72, v72 row_mirror row_mask:0xf bank_mask:0xf
    v_mov_b32 v73, v72
    s_nop 1
    v_permlane16_swap_b32 v72, v73
    v_add_f32 v72, v72, v73
    v_mov_b32 v73, v72
    s_nop 1
    v_permlane32_swap_b32 v72, v73
    v_add_f32 v72, v72, v73
    v_mul_f32 v72, 0x3b000000, v72
    v_cvt_pk_bf16_f32 v76, v72, v72
    v_lshlrev_b32 v76, 16, v76
    v_sub_f32 v64, v64, v72
    v_sub_f32 v65, v65, v72
    v_sub_f32 v66, v66, v72
    v_sub_f32 v67, v67, v72
    v_sub_f32 v68, v68, v72
    v_sub_f32 v69, v69, v72
    v_sub_f32 v70, v70, v72
    v_sub_f32 v71, v71, v72
    v_mul_f32 v74, v64, v64
    v_mul_f32 v75, v65, v65
    v_fmac_f32 v74, v66, v66
    v_fmac_f32 v75, v67, v67
    v_fmac_f32 v74, v68, v68
    v_fmac_f32 v75, v69, v69
    v_fmac_f32 v74, v70, v70
    v_fmac_f32 v75, v71, v71
    v_add_f32 v74, v74, v75
    s_nop 1
    v_add_f32_dpp v74, v74, v74 quad_perm:[1,0,3,2] row_mask:0xf bank_mask:0xf
    s_nop 1
    v_add_f32_dpp v74, v74, v74 quad_perm:[2,3,0,1] row_mask:0xf bank_mask:0xf
    s_nop 1
    v_add_f32_dpp v74, v74, v74 row_half_mirror row_mask:0xf bank_mask:0xf
    s_nop 1
    v_add_f32_dpp v74, v74, v74 row_mirror row_mask:0xf bank_mask:0xf
    v_mov_b32 v73, v74
    s_nop 1
    v_permlane16_swap_b32 v74, v73
    v_add_f32 v74, v74, v73
    v_mov_b32 v73, v74
    s_nop 1
    v_permlane32_swap_b32 v74, v73
    v_add_f32 v74, v74, v73
    v_mul_f32 v74, 0x3b000000, v74
    v_cvt_pk_bf16_f32 v74, v74, v74
    v_lshlrev_b32 v74, 16, v74
    v_add_f32 v74, 0x3727c5ac, v74
    v_cvt_pk_bf16_f32 v74, v74, v74
    v_lshlrev_b32 v74, 16, v74
    v_sqrt_f32 v74, v74
    s_nop 0
    v_cvt_pk_bf16_f32 v74, v74, v74
    v_lshlrev_b32 v74, 16, v74
    v_rcp_f32 v74, v74
    s_waitcnt vmcnt(8)
    v_lshlrev_b32 v80, 16, v12
    v_and_b32 v81, s47, v12
    v_lshlrev_b32 v82, 16, v13
    v_and_b32 v83, s47, v13
    v_lshlrev_b32 v84, 16, v14
    v_and_b32 v85, s47, v14
    v_lshlrev_b32 v86, 16, v15
    v_and_b32 v87, s47, v15
    v_sub_f32 v80, v80, v76
    v_sub_f32 v81, v81, v76
    v_sub_f32 v82, v82, v76
    v_sub_f32 v83, v83, v76
    v_sub_f32 v84, v84, v76
    v_sub_f32 v85, v85, v76
    v_sub_f32 v86, v86, v76
    v_sub_f32 v87, v87, v76
    v_cvt_pk_bf16_f32 v16, v80, v81
    v_cvt_pk_bf16_f32 v17, v82, v83
    v_cvt_pk_bf16_f32 v18, v84, v85
    v_cvt_pk_bf16_f32 v19, v86, v87
    v_lshlrev_b32 v64, 16, v16
    v_and_b32 v65, s47, v16
    v_lshlrev_b32 v66, 16, v17
    v_and_b32 v67, s47, v17
    v_lshlrev_b32 v68, 16, v18
    v_and_b32 v69, s47, v18
    v_lshlrev_b32 v70, 16, v19
    v_and_b32 v71, s47, v19
    v_mul_f32 v64, v64, v74
    v_mul_f32 v65, v65, v74
    v_mul_f32 v66, v66, v74
    v_mul_f32 v67, v67, v74
    v_mul_f32 v68, v68, v74
    v_mul_f32 v69, v69, v74
    v_mul_f32 v70, v70, v74
    v_mul_f32 v71, v71, v74
    v_cvt_pk_bf16_f32 v16, v64, v65
    v_cvt_pk_bf16_f32 v17, v66, v67
    v_cvt_pk_bf16_f32 v18, v68, v69
    v_cvt_pk_bf16_f32 v19, v70, v71
    s_waitcnt lgkmcnt(0)
    s_add_u32 s46, s37, 2654435769
    s_and_b32 s46, s46, 0xff
    v_mov_b32 v7, s46
    s_waitcnt vmcnt(6)
    v_perm_b32 v80, v36, v32, s38
    v_perm_b32 v81, v36, v32, s39
    v_perm_b32 v82, v37, v33, s38
    v_perm_b32 v83, v37, v33, s39
    v_perm_b32 v84, v38, v34, s38
    v_perm_b32 v85, v38, v34, s39
    v_perm_b32 v86, v39, v35, s38
    v_perm_b32 v87, v39, v35, s39
    v_dot2_f32_bf16 v96, v80, v16, 0
    v_dot2_f32_bf16 v97, v81, v16, 0
    v_dot2_f32_bf16 v98, v82, v16, 0
    v_dot2_f32_bf16 v99, v83, v16, 0
    v_dot2_f32_bf16 v100, v84, v16, 0
    v_dot2_f32_bf16 v101, v85, v16, 0
    v_dot2_f32_bf16 v102, v86, v16, 0
    v_dot2_f32_bf16 v103, v87, v16, 0
    s_waitcnt vmcnt(4)
    v_perm_b32 v80, v44, v40, s38
    v_perm_b32 v81, v44, v40, s39
    v_perm_b32 v82, v45, v41, s38
    v_perm_b32 v83, v45, v41, s39
    v_perm_b32 v84, v46, v42, s38
    v_perm_b32 v85, v46, v42, s39
    v_perm_b32 v86, v47, v43, s38
    v_perm_b32 v87, v47, v43, s39
    v_dot2_f32_bf16 v96, v80, v17, v96
    v_dot2_f32_bf16 v97, v81, v17, v97
    v_dot2_f32_bf16 v98, v82, v17, v98
    v_dot2_f32_bf16 v99, v83, v17, v99
    v_dot2_f32_bf16 v100, v84, v17, v100
    v_dot2_f32_bf16 v101, v85, v17, v101
    v_dot2_f32_bf16 v102, v86, v17, v102
    v_dot2_f32_bf16 v103, v87, v17, v103
    s_waitcnt vmcnt(2)
    v_perm_b32 v80, v52, v48, s38
    v_perm_b32 v81, v52, v48, s39
    v_perm_b32 v82, v53, v49, s38
    v_perm_b32 v83, v53, v49, s39
    v_perm_b32 v84, v54, v50, s38
    v_perm_b32 v85, v54, v50, s39
    v_perm_b32 v86, v55, v51, s38
    v_perm_b32 v87, v55, v51, s39
    v_dot2_f32_bf16 v96, v80, v18, v96
    v_dot2_f32_bf16 v97, v81, v18, v97
    v_dot2_f32_bf16 v98, v82, v18, v98
    v_dot2_f32_bf16 v99, v83, v18, v99
    v_dot2_f32_bf16 v100, v84, v18, v100
    v_dot2_f32_bf16 v101, v85, v18, v101
    v_dot2_f32_bf16 v102, v86, v18, v102
    v_dot2_f32_bf16 v103, v87, v18, v103
    s_waitcnt vmcnt(0)
    v_perm_b32 v80, v60, v56, s38
    v_perm_b32 v81, v60, v56, s39
    v_perm_b32 v82, v61, v57, s38
    v_perm_b32 v83, v61, v57, s39
    v_perm_b32 v84, v62, v58, s38
    v_perm_b32 v85, v62, v58, s39
    v_perm_b32 v86, v63, v59, s38
    v_perm_b32 v87, v63, v59, s39
    v_dot2_f32_bf16 v96, v80, v19, v96
    v_dot2_f32_bf16 v97, v81, v19, v97
    v_dot2_f32_bf16 v98, v82, v19, v98
    v_dot2_f32_bf16 v99, v83, v19, v99
    v_dot2_f32_bf16 v100, v84, v19, v100
    v_dot2_f32_bf16 v101, v85, v19, v101
    v_dot2_f32_bf16 v102, v86, v19, v102
    v_dot2_f32_bf16 v103, v87, v19, v103
    v_permlane32_swap_b32 v96, v100
    v_permlane32_swap_b32 v97, v101
    v_permlane32_swap_b32 v98, v102
    v_permlane32_swap_b32 v99, v103
    v_pk_add_f32 v[96:97], v[96:97], v[100:101]
    v_pk_add_f32 v[98:99], v[98:99], v[102:103]
    s_nop 1
    v_permlane16_swap_b32 v96, v98
    v_permlane16_swap_b32 v97, v99
    v_pk_add_f32 v[96:97], v[96:97], v[98:99]
    s_nop 1
    v_add_f32_dpp v30, v96, v96 row_ror:8 row_mask:0xf bank_mask:0x3
    s_nop 1
    v_add_f32_dpp v30, v97, v97 row_ror:8 row_mask:0xf bank_mask:0xc
    v_and_or_b32 v30, v30, s68, v7
    buffer_store_dword v30, v29, s[48:51], 0 offen sc1
    s_barrier
    v_lshlrev_b32 v104, 4, v5
    v_add_u32 v104, 140352, v104
    ds_write_b128 v104, v[16:19]
    s_waitcnt vmcnt(0) lgkmcnt(0)
    s_barrier
    s_lshl_b32 s41, s33, 9
    s_add_u32 s41, s41, s30
    s_add_u32 s41, s41, 73728
    v_lshlrev_b32 v64, 3, v0
    buffer_load_dword v65, v64, s[48:51], s41 offen
    s_add_u32 s37, s37, 2654435769
    s_and_b32 s46, s37, 0xff
    v_mov_b32 v7, s46
    s_and_b32 s45, s37, 3
    s_mul_i32 s45, s45, 0x8001
    s_and_b32 s45, s45, s69
    s_bfe_u32 s46, s37, 0x20002
    s_mul_i32 s46, s46, 0x8001
    s_and_b32 s46, s46, s69
    v_and_b32 v20, 1, v0
    v_lshlrev_b32 v20, 16, v20
    v_and_b32 v22, 2, v0
    v_lshlrev_b32 v22, 15, v22
    v_or_b32 v22, 1, v22
    v_mov_b32 v21, s45
    v_mov_b32 v23, s46
    v_and_b32 v24, 1, v3
    v_lshlrev_b32 v24, 16, v24
    v_and_b32 v26, 2, v3
    v_lshlrev_b32 v26, 15, v26
    v_or_b32 v26, 1, v26
    v_mov_b32 v25, s45
    v_mov_b32 v27, s46
    s_branch L_b0
L_not01:
    s_load_dword s37, s[28:29], 0
    s_cmp_ge_u32 s3, 4
    s_cbranch_scc1 L_loader
    s_mov_b32 s38, 0x05040100
    s_mov_b32 s39, 0x07060302
    s_mov_b32 s47, 0xffff0000
    s_mov_b32 s68, 0xffffff00
    s_mov_b32 s69, 0x00010001
    s_mov_b32 s16, 0x8000
    s_mul_i32 s30, s34, 266240
    s_mul_i32 s31, s36, 266240
    s_mul_i32 s17, s32, 4259840
    s_mov_b32 s48, s28
    s_mov_b32 s49, s29
    s_mov_b32 s50, 268435456
    s_mov_b32 s51, 0x00020000
    s_lshl_b32 s41, s33, 7
    s_add_u32 s41, s41, s30
    s_add_u32 s41, s41, 80896
    s_and_b32 s45, s2, 63
    s_lshl_b32 s46, s32, 6
    s_or_b32 s45, s45, s46
    s_and_b32 s46, s2, 64
    s_lshl_b32 s46, s46, 1
    s_or_b32 s45, s45, s46
    s_and_b32 s42, s45, 31
    s_mul_i32 s42, s42, 266240
    s_lshr_b32 s44, s45, 5
    s_lshl_b32 s44, s44, 7
    s_add_u32 s44, s44, s42
    s_add_u32 s44, s44, 79872
    s_cmp_eq_u32 s3, 2
    s_cselect_b32 s41, s41, s44
    v_mov_b32 v64, 0
    v_mov_b32 v65, 0
    v_mov_b32 v66, 0
    v_mov_b32 v67, 0
    s_mov_b64 exec, 0xff
    s_cbranch_scc1 L_nz
    buffer_store_dwordx4 v[64:67], v1, s[48:51], s41 offen sc1
L_nz:
    s_mov_b64 exec, -1
    s_mov_b32 s56, s10
    s_mov_b32 s57, s11
    s_mov_b32 s58, 4194304
    s_mov_b32 s59, 0x00020000
    s_and_b32 s11, s3, 1
    v_lshlrev_b32 v28, 13, v2
    v_lshl_add_u32 v28, v3, 4, v28
    s_lshl_b32 s42, s11, 18
    s_add_u32 s26, s43, s42
    s_add_u32 s27, s26, 131072
    s_add_u32 s44, s30, 65536
    v_and_b32 v104, 31, v0
    v_lshrrev_b32 v105, 5, v0
    v_lshlrev_b32 v106, 11, v105
    v_lshl_add_u32 v106, v104, 4, v106
    s_waitcnt lgkmcnt(0)
    buffer_load_dwordx4 v[128:131], v28, s[56:59], s26 offen offset:0
    buffer_load_dwordx4 v[132:135], v28, s[56:59], s26 offen offset:64
    buffer_load_dwordx4 v[136:139], v28, s[56:59], s26 offen offset:128
    buffer_load_dwordx4 v[140:143], v28, s[56:59], s26 offen offset:192
    buffer_load_dwordx4 v[144:147], v28, s[56:59], s27 offen offset:0
    buffer_load_dwordx4 v[148:151], v28, s[56:59], s27 offen offset:64
    buffer_load_dwordx4 v[152:155], v28, s[56:59], s27 offen offset:128
    buffer_load_dwordx4 v[156:159], v28, s[56:59], s27 offen offset:192
    s_lshl_b32 s42, s11, 8
    s_add_u32 s42, s42, 139840
    v_and_b32 v107, 1, v104
    v_lshlrev_b32 v107, 6, v107
    v_lshl_add_u32 v107, v105, 5, v107
    v_and_b32 v111, 14, v104
    v_add_u32 v107, v111, v107
    v_and_b32 v111, 16, v104
    v_lshl_add_u32 v107, v111, 3, v107
    v_add_u32 v107, s42, v107
    v_lshlrev_b32 v108, 4, v3
    v_add_u32 v108, s42, v108
    v_lshlrev_b32 v109, 5, v2
    v_lshl_add_u32 v109, v3, 3, v109
    v_lshrrev_b32 v110, 4, v109
    s_lshl_b32 s42, s33, 7
    s_add_u32 s41, s30, s42
    s_lshl_b32 s42, s11, 6
    s_add_u32 s41, s41, s42
    s_add_u32 s41, s41, 77824
    v_add_u32 v109, s41, v109
    s_add_u32 s37, s37, 2654435769
    s_and_b32 s46, s37, 0xff
    v_mov_b32 v7, s46
    s_and_b32 s45, s37, 3
    s_mul_i32 s45, s45, 0x8001
    s_and_b32 s45, s45, s69
    s_bfe_u32 s46, s37, 0x20002
    s_mul_i32 s46, s46, 0x8001
    s_and_b32 s46, s46, s69
    v_and_b32 v20, 1, v0
    v_lshlrev_b32 v20, 16, v20
    v_and_b32 v22, 2, v0
    v_lshlrev_b32 v22, 15, v22
    v_or_b32 v22, 1, v22
    v_mov_b32 v21, s45
    v_mov_b32 v23, s46
    v_and_b32 v24, 1, v3
    v_lshlrev_b32 v24, 16, v24
    v_and_b32 v26, 2, v3
    v_lshlrev_b32 v26, 15, v26
    v_or_b32 v26, 1, v26
    v_mov_b32 v25, s45
    v_mov_b32 v27, s46
    v_and_b32 v120, 1, v110
    v_lshlrev_b32 v120, 16, v120
    v_and_b32 v122, 2, v110
    v_lshlrev_b32 v122, 15, v122
    v_or_b32 v122, 1, v122
    v_mov_b32 v121, s45
    v_mov_b32 v123, s46
    v_and_b32 v110, 1, v3
    v_cmp_eq_u32 vcc, 1, v110
    s_nop 1
    v_cndmask_b32 v120, v120, v122, vcc
    v_cndmask_b32 v121, v121, v123, vcc
    s_setprio 3
    s_barrier
    s_barrier
    v_mov_b32 v111, 0x3e0293ee
    buffer_load_dwordx4 v[64:67], v106, s[48:51], s44 offen offset:0 sc1
    buffer_load_dwordx4 v[68:71], v106, s[48:51], s44 offen offset:512 sc1
    buffer_load_dwordx4 v[72:75], v106, s[48:51], s44 offen offset:1024 sc1
    buffer_load_dwordx4 v[76:79], v106, s[48:51], s44 offen offset:1536 sc1
    s_mov_b32 s40, 100000
L_h1_1:
    s_waitcnt vmcnt(0)
    v_xor_b32 v64, v64, v7
    v_xor_b32 v65, v65, v7
    v_xor_b32 v66, v66, v7
    v_xor_b32 v67, v67, v7
    v_xor_b32 v68, v68, v7
    v_xor_b32 v69, v69, v7
    v_xor_b32 v70, v70, v7
    v_xor_b32 v71, v71, v7
    v_xor_b32 v72, v72, v7
    v_xor_b32 v73, v73, v7
    v_xor_b32 v74, v74, v7
    v_xor_b32 v75, v75, v7
    v_xor_b32 v76, v76, v7
    v_xor_b32 v77, v77, v7
    v_xor_b32 v78, v78, v7
    v_xor_b32 v79, v79, v7
    v_or3_b32 v96, v64, v65, v66
    v_or3_b32 v96, v67, v68, v96
    v_or3_b32 v96, v69, v70, v96
    v_or3_b32 v96, v71, v72, v96
    v_or3_b32 v96, v73, v74, v96
    v_or3_b32 v96, v75, v76, v96
    v_or3_b32 v96, v77, v78, v96
    v_or_b32 v96, v79, v96
    v_and_b32 v96, 0xff, v96
    v_cmp_ne_u32 vcc, 0, v96
    s_cbranch_vccz L_h1d_2
    s_sub_u32 s40, s40, 1
    s_cbranch_scc1 L_h1d_2
    s_mov_b64 exec, vcc
    buffer_load_dwordx4 v[64:67], v106, s[48:51], s44 offen offset:0 sc1
    buffer_load_dwordx4 v[68:71], v106, s[48:51], s44 offen offset:512 sc1
    buffer_load_dwordx4 v[72:75], v106, s[48:51], s44 offen offset:1024 sc1
    buffer_load_dwordx4 v[76:79], v106, s[48:51], s44 offen offset:1536 sc1
    s_branch L_h1_1
L_h1d_2:
    s_mov_b64 exec, -1
    v_pk_add_f32 v[64:65], v[64:65], v[68:69]
    v_pk_add_f32 v[72:73], v[72:73], v[76:77]
    v_pk_add_f32 v[66:67], v[66:67], v[70:71]
    v_pk_add_f32 v[74:75], v[74:75], v[78:79]
    v_pk_add_f32 v[64:65], v[64:65], v[72:73]
    v_pk_add_f32 v[66:67], v[66:67], v[74:75]
    s_nop 1
    v_permlane32_swap_b32 v64, v66
    v_permlane32_swap_b32 v65, v67
    v_pk_add_f32 v[64:65], v[64:65], v[66:67]
    v_cvt_pk_bf16_f32 v64, v64, v65
    ds_write_b16 v107, v64
    ds_write_b16_d16_hi v107, v64 offset:16
    s_waitcnt lgkmcnt(0)
    ds_read_b128 v[80:83], v108 offset:0
    ds_read_b128 v[84:87], v108 offset:64
    ds_read_b128 v[88:91], v108 offset:128
    ds_read_b128 v[92:95], v108 offset:192
    s_waitcnt lgkmcnt(3)
    v_mfma_f32_16x16x32_bf16 v[112:115], v[128:131], v[80:83], 0
    v_mfma_f32_16x16x32_bf16 v[116:119], v[144:147], v[80:83], 0
    s_waitcnt lgkmcnt(2)
    v_mfma_f32_16x16x32_bf16 v[112:115], v[132:135], v[84:87], v[112:115]
    v_mfma_f32_16x16x32_bf16 v[116:119], v[148:151], v[84:87], v[116:119]
    s_waitcnt lgkmcnt(1)
    v_mfma_f32_16x16x32_bf16 v[112:115], v[136:139], v[88:91], v[112:115]
    v_mfma_f32_16x16x32_bf16 v[116:119], v[152:155], v[88:91], v[116:119]
    s_waitcnt lgkmcnt(0)
    v_mfma_f32_16x16x32_bf16 v[112:115], v[140:143], v[92:95], v[112:115]
    v_mfma_f32_16x16x32_bf16 v[116:119], v[156:159], v[92:95], v[116:119]
    s_mov_b32 exec_lo, 0x00020002
    s_mov_b32 exec_hi, 0x00020002
    s_nop 5
    v_mov_b32 v112, v116
    v_mov_b32 v113, v117
    v_mov_b32 v114, v118
    v_mov_b32 v115, v119
    s_mov_b32 exec_lo, 0x00030003
    s_mov_b32 exec_hi, 0x00030003
    v_mul_f32 v112, v111, v112
    v_mul_f32 v113, v111, v113
    v_mul_f32 v114, v111, v114
    v_mul_f32 v115, v111, v115
    v_add_u32 v112, 0x10000, v112
    v_add_u32 v113, 0x10000, v113
    v_add_u32 v114, 0x10000, v114
    v_add_u32 v115, 0x10000, v115
    v_perm_b32 v12, v113, v112, s39
    v_perm_b32 v13, v115, v114, s39
    v_bfi_b32 v12, s69, v120, v12
    v_bfi_b32 v13, s69, v121, v13
    buffer_store_dwordx2 v[12:13], v109, s[48:51], 0 offen sc1
    s_mov_b64 exec, -1
    s_branch L_b0
L_loader:
    s_mov_b32 s52, s6
    s_mov_b32 s53, s7
    s_mov_b32 s54, 16777216
    s_mov_b32 s55, 0x00020000
    s_mov_b32 s38, 0x05040100
    s_mov_b32 s39, 0x07060302
    s_mov_b32 s47, 0xffff0000
    s_mov_b32 s68, 0xffffff00
    s_mov_b32 s69, 0x00010001
    s_mov_b32 s16, 0x8000
    s_mul_i32 s30, s34, 266240
    s_mul_i32 s31, s36, 266240
    s_mul_i32 s17, s32, 4259840
    s_mov_b32 s48, s28
    s_mov_b32 s49, s29
    s_mov_b32 s50, 268435456
    s_mov_b32 s51, 0x00020000
    s_waitcnt lgkmcnt(0)
    s_add_u32 s37, s37, 2654435769
    s_and_b32 s46, s37, 0xff
    v_mov_b32 v7, s46
    s_and_b32 s45, s37, 3
    s_mul_i32 s45, s45, 0x8001
    s_and_b32 s45, s45, s69
    s_bfe_u32 s46, s37, 0x20002
    s_mul_i32 s46, s46, 0x8001
    s_and_b32 s46, s46, s69
    v_and_b32 v20, 1, v0
    v_lshlrev_b32 v20, 16, v20
    v_and_b32 v22, 2, v0
    v_lshlrev_b32 v22, 15, v22
    v_or_b32 v22, 1, v22
    v_mov_b32 v21, s45
    v_mov_b32 v23, s46
    v_and_b32 v24, 1, v3
    v_lshlrev_b32 v24, 16, v24
    v_and_b32 v26, 2, v3
    v_lshlrev_b32 v26, 15, v26
    v_or_b32 v26, 1, v26
    v_mov_b32 v25, s45
    v_mov_b32 v27, s46
    s_mul_i32 s27, s33, 229376
    s_lshl_b32 s44, s36, 7
    s_add_u32 s27, s27, s44
    s_and_b32 s42, s3, 1
    s_mul_i32 s42, s42, 114688
    s_add_u32 s27, s27, s42
    s_cmp_lt_u32 s36, 28
    s_cselect_b32 s58, 1835008, 0
    s_bitcmp0_b32 s3, 1
    s_cselect_b64 s[56:57], s[18:19], s[20:21]
    s_mov_b32 s59, 0x00020000
    v_mul_u32_u24 v13, 14336, v5
    v_lshl_add_u32 v13, v4, 4, v13
    v_add_u32 v14, 7168, v13
    s_sub_u32 s41, s3, 4
    s_lshl_b32 s42, s35, 17
    s_lshl_b32 s43, s41, 14
    s_add_u32 s42, s42, s43
    s_add_u32 s44, s42, 65536
    s_mul_i32 s43, s41, 16896
    s_barrier
    s_mov_b32 s8, s42
    s_mov_b32 s9, s43
    s_mov_b32 s10, s44
    s_add_u32 m0, s9, 0
    s_nop 0
    buffer_load_dwordx4 v1, s[52:55], s8 offen offset:0 nt lds
    s_waitcnt vmcnt(8)
    s_add_u32 m0, s9, 32
    s_nop 0
    buffer_load_dwordx4 v1, s[52:55], s8 offen offset:1024 nt lds
    s_waitcnt vmcnt(8)
    s_add_u32 m0, s9, 64
    s_nop 0
    buffer_load_dwordx4 v1, s[52:55], s8 offen offset:2048 nt lds
    s_waitcnt vmcnt(8)
    s_add_u32 m0, s9, 96
    s_nop 0
    buffer_load_dwordx4 v1, s[52:55], s8 offen offset:3072 nt lds
    s_waitcnt vmcnt(8)
    s_add_u32 s8, s8, 4096
    s_add_u32 s9, s9, 4224
    s_barrier
    s_add_u32 m0, s9, 0
    s_nop 0
    buffer_load_dwordx4 v1, s[52:55], s8 offen offset:0 nt lds
    s_waitcnt vmcnt(8)
    s_add_u32 m0, s9, 32
    s_nop 0
    buffer_load_dwordx4 v1, s[52:55], s8 offen offset:1024 nt lds
    s_waitcnt vmcnt(8)
    s_add_u32 m0, s9, 64
    s_nop 0
    buffer_load_dwordx4 v1, s[52:55], s8 offen offset:2048 nt lds
    s_waitcnt vmcnt(8)
    s_add_u32 m0, s9, 96
    s_nop 0
    buffer_load_dwordx4 v1, s[52:55], s8 offen offset:3072 nt lds
    s_waitcnt vmcnt(8)
    s_add_u32 s8, s8, 4096
    s_add_u32 s9, s9, 4224
    buffer_load_dwordx4 v[48:51], v13, s[56:59], s27 offen offset:0 nt
    s_waitcnt vmcnt(8)
    buffer_load_dwordx4 v[52:55], v13, s[56:59], s27 offen offset:3584 nt
    s_waitcnt vmcnt(8)
    buffer_load_dwordx4 v[56:59], v14, s[56:59], s27 offen offset:0 nt
    s_waitcnt vmcnt(8)
    buffer_load_dwordx4 v[60:63], v14, s[56:59], s27 offen offset:3584 nt
    s_waitcnt vmcnt(8)
    s_add_u32 m0, s9, 0
    s_nop 0
    buffer_load_dwordx4 v1, s[52:55], s8 offen offset:0 nt lds
    s_waitcnt vmcnt(8)
    s_add_u32 m0, s9, 32
    s_nop 0
    buffer_load_dwordx4 v1, s[52:55], s8 offen offset:1024 nt lds
    s_waitcnt vmcnt(8)
    s_add_u32 m0, s9, 64
    s_nop 0
    buffer_load_dwordx4 v1, s[52:55], s8 offen offset:2048 nt lds
    s_waitcnt vmcnt(8)
    s_add_u32 m0, s9, 96
    s_nop 0
    buffer_load_dwordx4 v1, s[52:55], s8 offen offset:3072 nt lds
    s_waitcnt vmcnt(8)
    s_add_u32 s8, s8, 4096
    s_add_u32 s9, s9, 4224
    s_add_u32 m0, s9, 0
    s_nop 0
    buffer_load_dwordx4 v1, s[52:55], s8 offen offset:0 nt lds
    s_waitcnt vmcnt(8)
    s_add_u32 m0, s9, 32
    s_nop 0
    buffer_load_dwordx4 v1, s[52:55], s8 offen offset:1024 nt lds
    s_waitcnt vmcnt(8)
    s_add_u32 m0, s9, 64
    s_nop 0
    buffer_load_dwordx4 v1, s[52:55], s8 offen offset:2048 nt lds
    s_waitcnt vmcnt(8)
    s_add_u32 m0, s9, 96
    s_nop 0
    buffer_load_dwordx4 v1, s[52:55], s8 offen offset:3072 nt lds
    s_waitcnt vmcnt(8)
    s_mov_b32 s8, s10
    s_add_u32 s9, s9, 54912
    s_add_u32 m0, s9, 0
    s_nop 0
    buffer_load_dwordx4 v1, s[52:55], s8 offen offset:0 nt lds
    s_waitcnt vmcnt(8)
    s_add_u32 m0, s9, 32
    s_nop 0
    buffer_load_dwordx4 v1, s[52:55], s8 offen offset:1024 nt lds
    s_waitcnt vmcnt(8)
    s_add_u32 m0, s9, 64
    s_nop 0
    buffer_load_dwordx4 v1, s[52:55], s8 offen offset:2048 nt lds
    s_waitcnt vmcnt(8)
    s_add_u32 m0, s9, 96
    s_nop 0
    buffer_load_dwordx4 v1, s[52:55], s8 offen offset:3072 nt lds
    s_waitcnt vmcnt(8)
    s_add_u32 s8, s8, 4096
    s_add_u32 s9, s9, 4224
    s_add_u32 m0, s9, 0
    s_nop 0
    buffer_load_dwordx4 v1, s[52:55], s8 offen offset:0 nt lds
    s_waitcnt vmcnt(8)
    s_add_u32 m0, s9, 32
    s_nop 0
    buffer_load_dwordx4 v1, s[52:55], s8 offen offset:1024 nt lds
    s_waitcnt vmcnt(8)
    s_add_u32 m0, s9, 64
    s_nop 0
    buffer_load_dwordx4 v1, s[52:55], s8 offen offset:2048 nt lds
    s_waitcnt vmcnt(8)
    s_add_u32 m0, s9, 96
    s_nop 0
    buffer_load_dwordx4 v1, s[52:55], s8 offen offset:3072 nt lds
    s_waitcnt vmcnt(8)
    s_add_u32 s8, s8, 4096
    s_add_u32 s9, s9, 4224
    s_add_u32 m0, s9, 0
    s_nop 0
    buffer_load_dwordx4 v1, s[52:55], s8 offen offset:0 nt lds
    s_waitcnt vmcnt(8)
    s_add_u32 m0, s9, 32
    s_nop 0
    buffer_load_dwordx4 v1, s[52:55], s8 offen offset:1024 nt lds
    s_waitcnt vmcnt(8)
    s_add_u32 m0, s9, 64
    s_nop 0
    buffer_load_dwordx4 v1, s[52:55], s8 offen offset:2048 nt lds
    s_waitcnt vmcnt(8)
    s_add_u32 m0, s9, 96
    s_nop 0
    buffer_load_dwordx4 v1, s[52:55], s8 offen offset:3072 nt lds
    s_waitcnt vmcnt(8)
    s_add_u32 s8, s8, 4096
    s_add_u32 s9, s9, 4224
    s_waitcnt vmcnt(12)
L_b0:
    s_mov_b32 s60, s14
    s_mov_b32 s61, s15
    s_mov_b32 s62, 4194304
    s_mov_b32 s63, 0x00020000
    s_mov_b32 s64, s22
    s_mov_b32 s65, s23
    s_mov_b32 s66, 1835008
    s_mov_b32 s67, 0x00020000
    s_mov_b32 s52, s12
    s_mov_b32 s53, s13
    s_mov_b32 s54, 4194304
    s_mov_b32 s55, 0x00020000
    s_mov_b32 s56, s6
    s_mov_b32 s57, s7
    s_mov_b32 s58, 16777216
    s_mov_b32 s59, 0x00020000
    s_lshl_b32 s41, s32, 6
    s_lshl_b32 s42, s3, 3
    s_add_u32 s41, s41, s42
    s_and_b32 s42, s2, 7
    s_add_u32 s41, s41, s42
    s_and_b32 s42, s41, 31
    s_mul_i32 s42, s42, 266240
    s_lshr_b32 s11, s41, 5
    s_lshl_b32 s11, s11, 7
    s_add_u32 s11, s11, s42
    s_add_u32 s11, s11, 79872
    s_lshl_b32 s41, s32, 6
    s_lshl_b32 s42, s33, 3
    s_add_u32 s41, s41, s42
    s_add_u32 s41, s41, s3
    s_and_b32 s42, s41, 31
    s_mul_i32 s42, s42, 266240
    s_lshr_b32 s18, s41, 5
    s_lshl_b32 s18, s18, 7
    s_add_u32 s18, s18, s42
    s_add_u32 s18, s18, 79872
    v_mul_u32_u24 v8, 1056, v2
    v_lshl_add_u32 v8, v3, 4, v8
    s_mul_i32 s41, s3, 16896
    v_add_u32 v9, s41, v8
    v_add_u32 v8, 144384, v8
    v_lshrrev_b32 v10, 2, v0
    v_mul_u32_u24 v10, 1056, v10
    v_and_b32 v11, 3, v0
    v_lshl_add_u32 v10, v11, 3, v10
    s_lshl_b32 s41, s3, 7
    v_add_u32 v10, s41, v10
    v_add_u32 v11, 67584, v10
    s_lshl_b32 s41, s33, 19
    s_lshl_b32 s42, s34, 8
    s_add_u32 s41, s41, s42
    s_and_b32 s42, s3, 3
    s_lshl_b32 s42, s42, 17
    s_add_u32 s26, s41, s42
    s_lshl_b32 s42, s33, 10
    s_add_u32 s27, s31, s42
    s_and_b32 s42, s3, 3
    s_lshl_b32 s42, s42, 8
    s_add_u32 s27, s27, s42
    s_add_u32 s27, s27, 81920
    s_and_b32 s42, s3, 1
    s_lshl_b32 s42, s42, 6
    s_add_u32 s42, s42, 140352
    v_lshl_add_u32 v15, v5, 3, s42
    v_lshlrev_b32 v13, 11, v5
    v_lshl_add_u32 v13, v4, 4, v13
    v_lshlrev_b32 v14, 13, v5
    v_lshl_add_u32 v14, v4, 4, v14
    v_lshrrev_b32 v28, 1, v2
    v_xor_b32 v28, v28, v3
    v_lshlrev_b32 v28, 5, v28
    v_and_b32 v29, 1, v0
    v_lshl_add_u32 v28, v29, 4, v28
    v_lshl_add_u32 v28, v3, 13, v28
    v_xor_b32 v29, 128, v28
    v_add_u32 v29, 32768, v29
    v_mul_u32_u24 v30, 134144, v4
    v_lshl_add_u32 v30, v3, 4, v30
    v_and_b32 v31, 8, v0
    v_lshl_add_u32 v30, v31, 3, v30
    s_mul_i32 s44, s32, 2146304
    s_mul_i32 s45, s3, 16768
    s_add_u32 s44, s44, s45
    s_lshl_b32 s45, s35, 7
    s_add_u32 s44, s44, s45
    s_add_u32 s44, s44, 10485760
    v_add_u32 v30, s44, v30
    v_add_u32 v31, 1073152, v30
    v_lshlrev_b32 v6, 4, v2
    v_add_u32 v6, 139264, v6
    s_lshl_b32 s43, s34, 17
    s_lshl_b32 s44, s33, 14
    s_add_u32 s43, s43, s44
    s_lshl_b32 s46, s3, 7
    s_add_u32 s6, s43, s46
    s_lshl_b32 s44, s36, 16
    s_add_u32 s46, s46, s44
    s_lshl_b32 s44, s33, 10
    s_add_u32 s7, s46, s44
    s_mul_i32 s44, s3, 4224
    s_add_u32 s44, s44, 144384
    v_add_u32 v12, s44, v1
    s_mul_i32 s41, s3, 1064960
    s_add_u32 s41, s41, s17
    s_add_u32 s41, s41, 77824
    s_add_u32 s42, s41, 266240
    s_add_u32 s43, s42, 266240
    s_add_u32 s44, s43, 266240
    s_add_u32 s45, s26, 65536
    s_cmp_ge_u32 s3, 4
    s_waitcnt lgkmcnt(0)
    s_barrier
    s_cbranch_scc1 L_ng
    buffer_load_dwordx4 v[64:67], v1, s[48:51], s41 offen sc1
    buffer_load_dwordx4 v[68:71], v1, s[48:51], s42 offen sc1
    buffer_load_dwordx4 v[72:75], v1, s[48:51], s43 offen sc1
    buffer_load_dwordx4 v[76:79], v1, s[48:51], s44 offen sc1
    ds_read_b64_tr_b16 v[192:193], v10 offset:0
    ds_read_b64_tr_b16 v[196:197], v10 offset:32
    ds_read_b64_tr_b16 v[200:201], v10 offset:64
    ds_read_b64_tr_b16 v[204:205], v10 offset:96
    ds_read_b64_tr_b16 v[208:209], v10 offset:16896
    ds_read_b64_tr_b16 v[212:213], v10 offset:16928
    ds_read_b64_tr_b16 v[216:217], v10 offset:16960
    ds_read_b64_tr_b16 v[220:221], v10 offset:16992
    s_waitcnt lgkmcnt(7)
    ds_read_b64_tr_b16 v[224:225], v10 offset:33792
    ds_read_b64_tr_b16 v[228:229], v10 offset:33824
    ds_read_b64_tr_b16 v[232:233], v10 offset:33856
    ds_read_b64_tr_b16 v[236:237], v10 offset:33888
    ds_read_b64_tr_b16 v[240:241], v10 offset:50688
    ds_read_b64_tr_b16 v[244:245], v10 offset:50720
    ds_read_b64_tr_b16 v[248:249], v10 offset:50752
    ds_read_b64_tr_b16 v[252:253], v10 offset:50784
    s_mov_b32 s40, 100000
L_h2g_3:
    s_waitcnt vmcnt(0)
    v_xor_b32 v64, v64, v20
    v_xor_b32 v65, v65, v21
    v_xor_b32 v66, v66, v22
    v_xor_b32 v67, v67, v23
    v_xor_b32 v68, v68, v20
    v_xor_b32 v69, v69, v21
    v_xor_b32 v70, v70, v22
    v_xor_b32 v71, v71, v23
    v_xor_b32 v72, v72, v20
    v_xor_b32 v73, v73, v21
    v_xor_b32 v74, v74, v22
    v_xor_b32 v75, v75, v23
    v_xor_b32 v76, v76, v20
    v_xor_b32 v77, v77, v21
    v_xor_b32 v78, v78, v22
    v_xor_b32 v79, v79, v23
    v_or3_b32 v96, v64, v65, v66
    v_or3_b32 v96, v67, v68, v96
    v_or3_b32 v96, v69, v70, v96
    v_or3_b32 v96, v71, v72, v96
    v_or3_b32 v96, v73, v74, v96
    v_or3_b32 v96, v75, v76, v96
    v_or3_b32 v96, v77, v78, v96
    v_or_b32 v96, v79, v96
    v_and_b32 v96, s69, v96
    v_cmp_ne_u32 vcc, 0, v96
    s_cbranch_vccz L_h2gd_4
    s_sub_u32 s40, s40, 1
    s_cbranch_scc1 L_h2gd_4
    s_wqm_b64 exec, vcc
    buffer_load_dwordx4 v[64:67], v1, s[48:51], s41 offen sc1
    buffer_load_dwordx4 v[68:71], v1, s[48:51], s42 offen sc1
    buffer_load_dwordx4 v[72:75], v1, s[48:51], s43 offen sc1
    buffer_load_dwordx4 v[76:79], v1, s[48:51], s44 offen sc1
    s_branch L_h2g_3
L_h2gd_4:
    s_mov_b64 exec, -1
    s_waitcnt lgkmcnt(8)
    ds_write_b128 v12, v[64:67] offset:0
    ds_write_b128 v12, v[68:71] offset:1056
    ds_write_b128 v12, v[72:75] offset:2112
    ds_write_b128 v12, v[76:79] offset:3168
    s_setprio 0
    v_add_u32 v76, 135168, v1
    s_waitcnt lgkmcnt(0)
    s_barrier
    buffer_load_dwordx4 v[48:51], v13, s[60:63], s6 offen nt
    buffer_load_dwordx4 v[52:55], v13, s[60:63], s6 offen offset:1024 nt
    buffer_load_dwordx4 v[56:59], v14, s[64:67], s7 offen nt
    s_barrier
    ds_read_b128 v[68:71], v6
    ds_read_b64_tr_b16 v[194:195], v11 offset:0
    ds_read_b64_tr_b16 v[198:199], v11 offset:32
    ds_read_b64_tr_b16 v[202:203], v11 offset:64
    ds_read_b64_tr_b16 v[206:207], v11 offset:96
    ds_read_b64_tr_b16 v[210:211], v11 offset:16896
    ds_read_b64_tr_b16 v[214:215], v11 offset:16928
    ds_read_b64_tr_b16 v[218:219], v11 offset:16960
    ds_read_b64_tr_b16 v[222:223], v11 offset:16992
    ds_read_b64_tr_b16 v[226:227], v11 offset:33792
    ds_read_b64_tr_b16 v[230:231], v11 offset:33824
    ds_read_b64_tr_b16 v[234:235], v11 offset:33856
    ds_read_b64_tr_b16 v[238:239], v11 offset:33888
    s_waitcnt lgkmcnt(7)
    ds_read_b64_tr_b16 v[242:243], v11 offset:50688
    ds_read_b64_tr_b16 v[246:247], v11 offset:50720
    ds_read_b64_tr_b16 v[250:251], v11 offset:50752
    ds_read_b64_tr_b16 v[254:255], v11 offset:50784
    v_max3_f32 v66, v68, v69, v70
    v_max_f32 v66, v66, v71
    v_and_b32 v66, s68, v66
    s_barrier
    ds_read_b128 v[80:83], v76 offset:0
    ds_read_b128 v[84:87], v76 offset:1024
    ds_read_b128 v[88:91], v76 offset:2048
    ds_read_b128 v[92:95], v76 offset:3072
    s_branch L_pv
L_ng:
    v_subrev_u32 v12, 67584, v9
    ds_read_b64 v[16:17], v15
    ds_read_b128 v[192:195], v12 offset:0
    ds_read_b128 v[196:199], v12 offset:64
    ds_read_b128 v[200:203], v12 offset:128
    ds_read_b128 v[204:207], v12 offset:192
    ds_read_b128 v[208:211], v12 offset:256
    ds_read_b128 v[212:215], v12 offset:320
    ds_read_b128 v[216:219], v12 offset:384
    ds_read_b128 v[220:223], v12 offset:448
    s_add_u32 m0, s9, 0
    s_nop 0
    buffer_load_dwordx4 v1, s[56:59], s8 offen offset:0 nt lds
    s_waitcnt vmcnt(8)
    s_add_u32 m0, s9, 32
    s_nop 0
    buffer_load_dwordx4 v1, s[56:59], s8 offen offset:1024 nt lds
    s_waitcnt vmcnt(8)
    s_add_u32 m0, s9, 64
    s_nop 0
    buffer_load_dwordx4 v1, s[56:59], s8 offen offset:2048 nt lds
    s_waitcnt vmcnt(8)
    s_add_u32 m0, s9, 96
    s_nop 0
    buffer_load_dwordx4 v1, s[56:59], s8 offen offset:3072 nt lds
    s_waitcnt vmcnt(8)
    s_waitcnt lgkmcnt(0)
    ds_read_b128 v[224:227], v12 offset:512
    ds_read_b128 v[228:231], v12 offset:576
    ds_read_b128 v[232:235], v12 offset:640
    ds_read_b128 v[236:239], v12 offset:704
    ds_read_b128 v[240:243], v12 offset:768
    ds_read_b128 v[244:247], v12 offset:832
    ds_read_b128 v[248:251], v12 offset:896
    ds_read_b128 v[252:255], v12 offset:960
    v_perm_b32 v64, v52, v48, s38
    v_perm_b32 v65, v52, v48, s39
    v_perm_b32 v66, v53, v49, s38
    v_perm_b32 v67, v53, v49, s39
    v_perm_b32 v68, v54, v50, s38
    v_perm_b32 v69, v54, v50, s39
    v_perm_b32 v70, v55, v51, s38
    v_perm_b32 v71, v55, v51, s39
    v_dot2_f32_bf16 v72, v64, v16, 0
    v_dot2_f32_bf16 v73, v65, v16, 0
    v_dot2_f32_bf16 v74, v66, v16, 0
    v_dot2_f32_bf16 v75, v67, v16, 0
    v_dot2_f32_bf16 v76, v68, v16, 0
    v_dot2_f32_bf16 v77, v69, v16, 0
    v_dot2_f32_bf16 v78, v70, v16, 0
    v_dot2_f32_bf16 v79, v71, v16, 0
    v_perm_b32 v64, v60, v56, s38
    v_perm_b32 v65, v60, v56, s39
    v_perm_b32 v66, v61, v57, s38
    v_perm_b32 v67, v61, v57, s39
    v_perm_b32 v68, v62, v58, s38
    v_perm_b32 v69, v62, v58, s39
    v_perm_b32 v70, v63, v59, s38
    v_perm_b32 v71, v63, v59, s39
    v_dot2_f32_bf16 v72, v64, v17, v72
    v_dot2_f32_bf16 v73, v65, v17, v73
    v_dot2_f32_bf16 v74, v66, v17, v74
    v_dot2_f32_bf16 v75, v67, v17, v75
    v_dot2_f32_bf16 v76, v68, v17, v76
    v_dot2_f32_bf16 v77, v69, v17, v77
    v_dot2_f32_bf16 v78, v70, v17, v78
    v_dot2_f32_bf16 v79, v71, v17, v79
    v_permlane32_swap_b32 v72, v76
    v_permlane32_swap_b32 v73, v77
    v_permlane32_swap_b32 v74, v78
    v_permlane32_swap_b32 v75, v79
    v_pk_add_f32 v[72:73], v[72:73], v[76:77]
    v_pk_add_f32 v[74:75], v[74:75], v[78:79]
    s_nop 1
    v_permlane16_swap_b32 v72, v74
    v_permlane16_swap_b32 v73, v75
    v_pk_add_f32 v[72:73], v[72:73], v[74:75]
    s_nop 1
    v_add_f32_dpp v18, v72, v72 row_ror:8 row_mask:0xf bank_mask:0x3
    s_nop 1
    v_add_f32_dpp v18, v73, v73 row_ror:8 row_mask:0xf bank_mask:0xc
    v_and_or_b32 v18, v18, s68, v7
    v_lshlrev_b32 v19, 2, v0
    v_mov_b32 v16, v13
    v_mov_b32 v17, v14

    s_waitcnt lgkmcnt(0)
    s_barrier
    ds_read_b128 v[64:67], v8 offset:0
    ds_read_b128 v[68:71], v8 offset:64
    ds_read_b128 v[72:75], v8 offset:128
    ds_read_b128 v[76:79], v8 offset:192
    ds_read_b128 v[80:83], v8 offset:256
    ds_read_b128 v[84:87], v8 offset:320
    ds_read_b128 v[88:91], v8 offset:384
    ds_read_b128 v[92:95], v8 offset:448
    ds_read_b128 v[96:99], v8 offset:512
    ds_read_b128 v[100:103], v8 offset:576
    ds_read_b128 v[104:107], v8 offset:640
    ds_read_b128 v[108:111], v8 offset:704
    s_waitcnt lgkmcnt(11)
    v_mfma_f32_16x16x32_bf16 v[12:15], v[192:195], v[64:67], 0
    ds_read_b128 v[112:115], v8 offset:768
    s_waitcnt lgkmcnt(11)
    v_mfma_f32_16x16x32_bf16 v[12:15], v[196:199], v[68:71], v[12:15]
    ds_read_b128 v[116:119], v8 offset:832
    s_waitcnt lgkmcnt(11)
    v_mfma_f32_16x16x32_bf16 v[12:15], v[200:203], v[72:75], v[12:15]
    ds_read_b128 v[120:123], v8 offset:896
    s_waitcnt lgkmcnt(11)
    v_mfma_f32_16x16x32_bf16 v[12:15], v[204:207], v[76:79], v[12:15]
    ds_read_b128 v[124:127], v8 offset:960
    s_waitcnt lgkmcnt(11)
    v_mfma_f32_16x16x32_bf16 v[12:15], v[208:211], v[80:83], v[12:15]
    s_waitcnt lgkmcnt(10)
    v_mfma_f32_16x16x32_bf16 v[12:15], v[212:215], v[84:87], v[12:15]
    s_waitcnt lgkmcnt(9)
    v_mfma_f32_16x16x32_bf16 v[12:15], v[216:219], v[88:91], v[12:15]
    s_waitcnt lgkmcnt(8)
    v_mfma_f32_16x16x32_bf16 v[12:15], v[220:223], v[92:95], v[12:15]
    s_waitcnt lgkmcnt(7)
    v_mfma_f32_16x16x32_bf16 v[12:15], v[224:227], v[96:99], v[12:15]
    s_waitcnt lgkmcnt(6)
    v_mfma_f32_16x16x32_bf16 v[12:15], v[228:231], v[100:103], v[12:15]
    s_waitcnt lgkmcnt(5)
    v_mfma_f32_16x16x32_bf16 v[12:15], v[232:235], v[104:107], v[12:15]
    s_waitcnt lgkmcnt(4)
    v_mfma_f32_16x16x32_bf16 v[12:15], v[236:239], v[108:111], v[12:15]
    s_waitcnt lgkmcnt(3)
    v_mfma_f32_16x16x32_bf16 v[12:15], v[240:243], v[112:115], v[12:15]
    s_waitcnt lgkmcnt(2)
    v_mfma_f32_16x16x32_bf16 v[12:15], v[244:247], v[116:119], v[12:15]
    s_waitcnt lgkmcnt(1)
    v_mfma_f32_16x16x32_bf16 v[12:15], v[248:251], v[120:123], v[12:15]
    s_waitcnt lgkmcnt(0)
    v_mfma_f32_16x16x32_bf16 v[12:15], v[252:255], v[124:127], v[12:15]
    ds_read_b64_tr_b16 v[192:193], v10 offset:0
    ds_read_b64_tr_b16 v[196:197], v10 offset:32
    ds_read_b64_tr_b16 v[200:201], v10 offset:64
    ds_read_b64_tr_b16 v[204:205], v10 offset:96
    ds_read_b64_tr_b16 v[208:209], v10 offset:16896
    ds_read_b64_tr_b16 v[212:213], v10 offset:16928
    ds_read_b64_tr_b16 v[216:217], v10 offset:16960
    ds_read_b64_tr_b16 v[220:221], v10 offset:16992
    s_waitcnt vmcnt(7)
    buffer_load_dwordx4 v[32:35], v28, s[52:55], s26 offen nt
    s_waitcnt vmcnt(7)
    buffer_load_dwordx4 v[36:39], v29, s[52:55], s26 offen nt
    s_waitcnt vmcnt(7)
    buffer_load_dwordx4 v[40:43], v28, s[52:55], s45 offen nt
    s_waitcnt vmcnt(7)
    buffer_load_dwordx4 v[44:47], v29, s[52:55], s45 offen nt
    s_waitcnt vmcnt(7)
    buffer_load_dwordx4 v[48:51], v16, s[60:63], s6 offen nt
    s_waitcnt vmcnt(7)
    buffer_load_dwordx4 v[52:55], v16, s[60:63], s6 offen offset:1024 nt
    s_waitcnt vmcnt(7)
    buffer_load_dwordx4 v[56:59], v17, s[64:67], s7 offen nt
    s_waitcnt lgkmcnt(7)
    ds_read_b64_tr_b16 v[224:225], v10 offset:33792
    ds_read_b64_tr_b16 v[228:229], v10 offset:33824
    ds_read_b64_tr_b16 v[232:233], v10 offset:33856
    ds_read_b64_tr_b16 v[236:237], v10 offset:33888
    ds_read_b64_tr_b16 v[240:241], v10 offset:50688
    ds_read_b64_tr_b16 v[244:245], v10 offset:50720
    ds_read_b64_tr_b16 v[248:249], v10 offset:50752
    ds_read_b64_tr_b16 v[252:253], v10 offset:50784
    s_setprio 3
    s_waitcnt vmcnt(7) lgkmcnt(3)
    ds_read_b128 v[128:131], v9 offset:0
    ds_read_b128 v[132:135], v9 offset:64
    ds_read_b128 v[136:139], v9 offset:128
    ds_read_b128 v[140:143], v9 offset:192
    ds_read_b128 v[144:147], v9 offset:256
    ds_read_b128 v[148:151], v9 offset:320
    ds_read_b128 v[152:155], v9 offset:384
    ds_read_b128 v[156:159], v9 offset:448
    ds_read_b128 v[160:163], v9 offset:512
    ds_read_b128 v[164:167], v9 offset:576
    ds_read_b128 v[168:171], v9 offset:640
    ds_read_b128 v[172:175], v9 offset:704
    buffer_store_dword v18, v19, s[48:51], s27 offen sc1
    s_and_b32 s41, s3, 3
    s_lshl_b32 s43, s41, 2
    s_lshl_b32 s41, s41, 10
    s_add_u32 s44, s41, 135168
    v_add_u32 v28, s43, v6
    v_add_u32 v29, s44, v1
    v_max3_f32 v16, v12, v13, v14
    s_waitcnt lgkmcnt(11)
    v_mfma_f32_16x16x32_bf16 v[60:63], v[128:131], v[64:67], 0
    ds_read_b128 v[176:179], v9 offset:768
    s_waitcnt lgkmcnt(11)
    v_mfma_f32_16x16x32_bf16 v[60:63], v[132:135], v[68:71], v[60:63]
    ds_read_b128 v[180:183], v9 offset:832
    s_waitcnt lgkmcnt(11)
    v_mfma_f32_16x16x32_bf16 v[60:63], v[136:139], v[72:75], v[60:63]
    ds_read_b128 v[184:187], v9 offset:896
    s_waitcnt lgkmcnt(11)
    v_mfma_f32_16x16x32_bf16 v[60:63], v[140:143], v[76:79], v[60:63]
    ds_read_b128 v[188:191], v9 offset:960
    s_waitcnt lgkmcnt(11)
    v_mfma_f32_16x16x32_bf16 v[60:63], v[144:147], v[80:83], v[60:63]
    s_waitcnt lgkmcnt(10)
    v_mfma_f32_16x16x32_bf16 v[60:63], v[148:151], v[84:87], v[60:63]
    s_waitcnt lgkmcnt(9)
    v_mfma_f32_16x16x32_bf16 v[60:63], v[152:155], v[88:91], v[60:63]
    s_waitcnt lgkmcnt(8)
    v_mfma_f32_16x16x32_bf16 v[60:63], v[156:159], v[92:95], v[60:63]
    s_waitcnt lgkmcnt(7)
    v_mfma_f32_16x16x32_bf16 v[60:63], v[160:163], v[96:99], v[60:63]
    s_waitcnt lgkmcnt(6)
    v_mfma_f32_16x16x32_bf16 v[60:63], v[164:167], v[100:103], v[60:63]
    s_waitcnt lgkmcnt(5)
    v_mfma_f32_16x16x32_bf16 v[60:63], v[168:171], v[104:107], v[60:63]
    s_waitcnt lgkmcnt(4)
    v_mfma_f32_16x16x32_bf16 v[60:63], v[172:175], v[108:111], v[60:63]
    s_waitcnt lgkmcnt(3)
    v_mfma_f32_16x16x32_bf16 v[60:63], v[176:179], v[112:115], v[60:63]
    s_waitcnt lgkmcnt(2)
    v_mfma_f32_16x16x32_bf16 v[60:63], v[180:183], v[116:119], v[60:63]
    s_waitcnt lgkmcnt(1)
    v_mfma_f32_16x16x32_bf16 v[60:63], v[184:187], v[120:123], v[60:63]
    s_waitcnt lgkmcnt(0)
    v_mfma_f32_16x16x32_bf16 v[60:63], v[188:191], v[124:127], v[60:63]
    v_add_u32 v76, 135168, v1
    s_nop 6
    v_max3_f32 v67, v60, v61, v62
    v_max3_f32 v66, v16, v15, v63
    v_max_f32 v66, v66, v67
    v_mov_b32 v67, v66
    s_nop 1
    v_permlane16_swap_b32 v66, v67
    v_max_f32 v66, v66, v67
    v_mov_b32 v67, v66
    s_nop 1
    v_permlane32_swap_b32 v66, v67
    v_max_f32 v66, v66, v67
    ds_write_b32 v28, v66
    s_waitcnt lgkmcnt(0)
    s_barrier
    ds_read_b128 v[68:71], v6
    ds_read_b64_tr_b16 v[194:195], v11 offset:0
    ds_read_b64_tr_b16 v[198:199], v11 offset:32
    ds_read_b64_tr_b16 v[202:203], v11 offset:64
    ds_read_b64_tr_b16 v[206:207], v11 offset:96
    ds_read_b64_tr_b16 v[210:211], v11 offset:16896
    ds_read_b64_tr_b16 v[214:215], v11 offset:16928
    ds_read_b64_tr_b16 v[218:219], v11 offset:16960
    ds_read_b64_tr_b16 v[222:223], v11 offset:16992
    s_waitcnt lgkmcnt(8)
    v_max3_f32 v66, v68, v69, v70
    v_max_f32 v66, v66, v71
    v_and_b32 v66, s68, v66
    v_sub_f32 v12, v12, v66
    v_sub_f32 v13, v13, v66
    v_sub_f32 v14, v14, v66
    v_sub_f32 v15, v15, v66
    v_sub_f32 v60, v60, v66
    v_sub_f32 v61, v61, v66
    v_sub_f32 v62, v62, v66
    v_sub_f32 v63, v63, v66
    v_exp_f32 v12, v12
    v_exp_f32 v13, v13
    v_exp_f32 v14, v14
    v_exp_f32 v15, v15
    v_exp_f32 v60, v60
    v_exp_f32 v61, v61
    v_exp_f32 v62, v62
    v_exp_f32 v63, v63
    v_cvt_pk_bf16_f32 v68, v12, v13
    v_cvt_pk_bf16_f32 v69, v14, v15
    v_cvt_pk_bf16_f32 v70, v60, v61
    v_cvt_pk_bf16_f32 v71, v62, v63
    s_waitcnt lgkmcnt(6)
    ds_write_b128 v29, v[68:71]
    ds_read_b64_tr_b16 v[226:227], v11 offset:33792
    ds_read_b64_tr_b16 v[230:231], v11 offset:33824
    ds_read_b64_tr_b16 v[234:235], v11 offset:33856
    ds_read_b64_tr_b16 v[238:239], v11 offset:33888
    ds_read_b64_tr_b16 v[242:243], v11 offset:50688
    ds_read_b64_tr_b16 v[246:247], v11 offset:50720
    ds_read_b64_tr_b16 v[250:251], v11 offset:50752
    ds_read_b64_tr_b16 v[254:255], v11 offset:50784
    s_waitcnt lgkmcnt(8)
    s_setprio 0
    s_barrier
    ds_read_b128 v[80:83], v76 offset:0
    ds_read_b128 v[84:87], v76 offset:1024
    ds_read_b128 v[88:91], v76 offset:2048
    ds_read_b128 v[92:95], v76 offset:3072
L_pv:
    v_mov_b32 v77, 1
    s_cmp_lg_u32 s3, 2
    s_cbranch_scc1 L_noml
    v_mov_b32 v148, 0x3f803f80
    v_mov_b32 v149, 0x3f803f80
    v_mov_b32 v150, 0x3f803f80
    v_mov_b32 v151, 0x3f803f80
    v_lshlrev_b32 v75, 3, v0
    s_lshl_b32 s44, s32, 14
    s_lshl_b32 s45, s35, 7
    s_add_u32 s44, s44, s45
    s_add_u32 s44, s44, 9437184
    v_or_b32 v108, v66, v7
    s_waitcnt lgkmcnt(3)
    v_mfma_f32_16x16x32_bf16 v[144:147], v[148:151], v[80:83], 0
    s_waitcnt lgkmcnt(2)
    v_mfma_f32_16x16x32_bf16 v[144:147], v[148:151], v[84:87], v[144:147]
    s_waitcnt lgkmcnt(1)
    v_mfma_f32_16x16x32_bf16 v[144:147], v[148:151], v[88:91], v[144:147]
    s_waitcnt lgkmcnt(0)
    v_mfma_f32_16x16x32_bf16 v[144:147], v[148:151], v[92:95], v[144:147]
    s_nop 7
    v_and_or_b32 v109, v144, s68, v7
    s_mov_b64 exec, 0xffff
    buffer_store_dwordx2 v[108:109], v75, s[48:51], s44 offen sc1
    s_mov_b64 exec, -1
L_noml:
    s_waitcnt lgkmcnt(3)
    v_mfma_f32_16x16x32_bf16 v[128:131], v[192:195], v[80:83], 0
    v_mfma_f32_16x16x32_bf16 v[132:135], v[196:199], v[80:83], 0
    v_mfma_f32_16x16x32_bf16 v[136:139], v[200:203], v[80:83], 0
    v_mfma_f32_16x16x32_bf16 v[140:143], v[204:207], v[80:83], 0
    s_waitcnt lgkmcnt(2)
    v_mfma_f32_16x16x32_bf16 v[128:131], v[208:211], v[84:87], v[128:131]
    v_mfma_f32_16x16x32_bf16 v[132:135], v[212:215], v[84:87], v[132:135]
    v_mfma_f32_16x16x32_bf16 v[136:139], v[216:219], v[84:87], v[136:139]
    v_mfma_f32_16x16x32_bf16 v[140:143], v[220:223], v[84:87], v[140:143]
    s_waitcnt lgkmcnt(1)
    v_mfma_f32_16x16x32_bf16 v[128:131], v[224:227], v[88:91], v[128:131]
    v_mfma_f32_16x16x32_bf16 v[132:135], v[228:231], v[88:91], v[132:135]
    v_mfma_f32_16x16x32_bf16 v[136:139], v[232:235], v[88:91], v[136:139]
    v_mfma_f32_16x16x32_bf16 v[140:143], v[236:239], v[88:91], v[140:143]
    s_waitcnt lgkmcnt(0)
    v_mfma_f32_16x16x32_bf16 v[128:131], v[240:243], v[92:95], v[128:131]
    v_mfma_f32_16x16x32_bf16 v[132:135], v[244:247], v[92:95], v[132:135]
    v_mfma_f32_16x16x32_bf16 v[136:139], v[248:251], v[92:95], v[136:139]
    v_mfma_f32_16x16x32_bf16 v[140:143], v[252:255], v[92:95], v[140:143]
    s_nop 4
    v_cvt_pk_bf16_f32 v96, v128, v129
    v_cvt_pk_bf16_f32 v97, v130, v131
    v_bfi_b32 v104, s69, v24, v96
    v_bfi_b32 v105, s69, v25, v97
    v_bfi_b32 v96, s69, v24, v96
    v_bfi_b32 v97, s69, v25, v97
    v_cvt_pk_bf16_f32 v98, v132, v133
    v_cvt_pk_bf16_f32 v99, v134, v135
    v_bfi_b32 v106, s69, v26, v98
    v_bfi_b32 v107, s69, v27, v99
    v_bfi_b32 v98, s69, v26, v98
    v_bfi_b32 v99, s69, v27, v99
    v_cvt_pk_bf16_f32 v100, v136, v137
    v_cvt_pk_bf16_f32 v101, v138, v139
    v_bfi_b32 v100, s69, v24, v100
    v_bfi_b32 v101, s69, v25, v101
    v_cvt_pk_bf16_f32 v102, v140, v141
    v_cvt_pk_bf16_f32 v103, v142, v143
    v_bfi_b32 v102, s69, v26, v102
    v_bfi_b32 v103, s69, v27, v103
    s_mov_b64 exec, 1
    buffer_atomic_add v77, off, s[48:51], s11 sc1
    s_mov_b64 exec, -1
    v_mov_b32_dpp v96, v100 row_ror:8 row_mask:0xf bank_mask:0xc
    v_mov_b32_dpp v97, v101 row_ror:8 row_mask:0xf bank_mask:0xc
    v_mov_b32_dpp v98, v102 row_ror:8 row_mask:0xf bank_mask:0xc
    v_mov_b32_dpp v99, v103 row_ror:8 row_mask:0xf bank_mask:0xc
    buffer_store_dwordx4 v[96:99], v30, s[48:51], 0 offen sc1
    v_mov_b32_dpp v100, v104 row_ror:8 row_mask:0xf bank_mask:0x3
    v_mov_b32_dpp v101, v105 row_ror:8 row_mask:0xf bank_mask:0x3
    v_mov_b32_dpp v102, v106 row_ror:8 row_mask:0xf bank_mask:0x3
    v_mov_b32_dpp v103, v107 row_ror:8 row_mask:0xf bank_mask:0x3
    buffer_store_dwordx4 v[100:103], v31, s[48:51], 0 offen sc1
    s_mov_b64 exec, 1
    v_mov_b32 v126, 0
    buffer_atomic_add v126, off, s[48:51], s18 sc0 sc1
    s_mov_b64 exec, -1
    s_lshr_b32 s14, s2, 4
    s_and_b32 s14, s14, 7
    s_lshl_b32 s15, s3, 3
    s_add_u32 s15, s15, s14
    s_add_u32 s15, s15, 128
    s_and_b32 s14, s15, 31
    s_mul_i32 s14, s14, 266240
    s_lshr_b32 s12, s15, 5
    s_lshl_b32 s12, s12, 7
    s_add_u32 s12, s12, s14
    s_add_u32 s12, s12, 79872
    s_sub_u32 s13, s36, 24
    s_and_b32 s13, s13, 7
    s_lshl_b32 s15, s13, 3
    s_add_u32 s14, s15, s3
    s_add_u32 s14, s14, 128
    s_and_b32 s10, s14, 31
    s_mul_i32 s10, s10, 266240
    s_lshr_b32 s11, s14, 5
    s_lshl_b32 s11, s11, 7
    s_add_u32 s11, s11, s10
    s_add_u32 s11, s11, 79872
    s_add_u32 s15, s15, s33
    s_mul_i32 s8, s15, 16576
    s_lshl_b32 s9, s3, 10
    s_add_u32 s8, s8, s9
    s_add_u32 s8, s8, 20971520
    s_add_u32 s9, s8, 8192
    s_lshl_b32 s13, s13, 6
    s_add_u32 s13, s13, s33
    s_lshl_b32 s13, s13, 1
    v_lshl_add_u32 v176, v4, 4, s13
    v_bfe_u32 v177, v0, 4, 1
    v_lshlrev_b32 v177, 8, v177
    v_and_b32 v178, 3, v0
    v_lshl_add_u32 v177, v178, 6, v177
    v_lshrrev_b32 v178, 5, v0
    v_lshl_add_u32 v177, v178, 5, v177
    s_lshl_b32 s14, s3, 2
    s_add_u32 s14, s14, 140560
    v_add_u32 v177, s14, v177
    v_lshlrev_b32 v178, 5, v4
    v_add_u32 v178, 140560, v178
    s_cmp_lt_u32 s3, 4
    s_cbranch_scc1 L_pc0
    s_lshl_b32 s41, s3, 12
    s_add_u32 s41, s41, 128000
    v_add_u32 v9, s41, v1
    s_waitcnt vmcnt(8)
    ds_write_b128 v9, v[32:35] offset:0
    ds_write_b128 v9, v[36:39] offset:1024
    ds_write_b128 v9, v[40:43] offset:2048
    ds_write_b128 v9, v[44:47] offset:3072
L_pc0:
    v_lshlrev_b32 v8, 7, v5
    s_lshl_b32 s41, s32, 14
    s_lshl_b32 s42, s3, 11
    s_add_u32 s41, s41, s42
    s_and_b32 s42, s34, 15
    s_lshl_b32 s42, s42, 3
    s_add_u32 s41, s41, s42
    s_add_u32 s41, s41, 9437184
    s_mul_i32 s42, s34, 134144
    s_mul_i32 s43, s33, 16768
    s_add_u32 s42, s42, s43
    s_lshl_b32 s43, s3, 11
    s_add_u32 s42, s42, s43
    s_add_u32 s42, s42, 10485760
    s_lshl_b32 s43, s3, 3
    s_add_u32 s43, s43, 139776
    v_mov_b32 v74, s43
    v_bfe_u32 v75, v0, 3, 1
    v_mul_u32_u24 v75, 160, v75
    v_lshl_add_u32 v75, v4, 4, v75
    v_lshl_add_u32 v75, v3, 2, v75
    s_mul_i32 s43, s3, 320
    s_add_u32 s43, s43, 141584
    v_add_u32 v75, s43, v75
    v_mul_u32_u24 v76, 160, v2
    v_lshl_add_u32 v76, v3, 4, v76
    v_add_u32 v76, 141584, v76
    v_lshrrev_b32 v77, 2, v0
    v_and_b32 v78, 7, v77
    v_xor_b32 v78, s3, v78
    v_lshlrev_b32 v77, 8, v77
    v_lshl_add_u32 v77, v78, 5, v77
    v_and_b32 v78, 3, v0
    v_lshl_add_u32 v77, v78, 3, v77
    v_add_u32 v77, 144384, v77
    v_lshlrev_b32 v78, 3, v4
    v_add_u32 v78, 139776, v78
    v_lshlrev_b32 v79, 4, v3
    v_add_u32 v79, 139776, v79
    v_mov_b32 v14, s16
    s_lshl_b32 s43, s3, 9
    s_add_u32 s43, s30, s43
    s_lshl_b32 s44, s33, 6
    s_add_u32 s43, s43, s44
    s_add_u32 s43, s43, 69632
    v_lshl_add_u32 v15, v0, 2, s43
    s_lshl_b32 s43, s33, 9
    s_add_u32 s43, s30, s43
    s_add_u32 s43, s43, 69632
    v_lshlrev_b32 v9, 6, v4
    v_lshl_add_u32 v9, v5, 3, v9
    v_mul_u32_u24 v11, 16576, v5
    v_lshl_add_u32 v11, v4, 3, v11
    s_mul_i32 s44, s3, 132608
    s_lshl_b32 s45, s2, 6
    s_add_u32 s44, s44, s45
    s_add_u32 s44, s44, 20971520
    v_lshlrev_b32 v10, 10, v4
    v_lshl_add_u32 v10, v5, 2, v10
    s_lshl_b32 s45, s33, 5
    s_add_u32 s45, s31, s45
    s_add_u32 s45, s45, 81920
    s_lshl_b32 s26, s3, 7
    s_add_u32 s26, s26, s30
    s_add_u32 s26, s26, 80896
    s_lshl_b32 s27, s33, 7
    s_add_u32 s27, s27, s30
    s_add_u32 s27, s27, 80896
    v_mov_b32 v12, 1
    v_lshlrev_b32 v13, 3, v5
    v_add_u32 v13, 140496, v13
    s_and_b32 s46, s2, 7
    s_mov_b64 exec, 1
    s_mov_b32 s40, 200
    s_branch L_c3w_7
L_c3_5:

    v_mov_b32 v126, 0
    buffer_atomic_add v126, off, s[48:51], s18 sc0 sc1
    s_sub_u32 s40, s40, 1
    s_cbranch_scc1 L_c3d_6
L_c3w_7:
    s_waitcnt vmcnt(0)
    v_cmp_gt_u32 vcc, 16, v126
    s_cbranch_vccnz L_c3_5
L_c3d_6:
    s_mov_b64 exec, -1
    s_mov_b32 s40, 100000
    s_cmp_lg_u32 s46, s3
    s_cbranch_scc1 L_h3
    buffer_load_dword v104, v10, s[48:51], s45 offen offset:0 sc1
    buffer_load_dword v105, v10, s[48:51], s45 offen offset:256 sc1
    buffer_load_dword v106, v10, s[48:51], s45 offen offset:512 sc1
    buffer_load_dword v107, v10, s[48:51], s45 offen offset:768 sc1
L_h3:
    buffer_load_dwordx2 v[64:65], v8, s[48:51], s41 offen sc1
    buffer_load_dwordx2 v[68:69], v8, s[48:51], s41 offen offset:1024 sc1
    buffer_load_dwordx4 v[80:83], v1, s[48:51], s42 offen sc1
    buffer_load_dwordx4 v[84:87], v1, s[48:51], s42 offen offset:1024 sc1
    v_lshlrev_b32 v168, 16, v56
    v_and_b32 v169, s47, v56
    v_lshlrev_b32 v170, 16, v57
    v_and_b32 v171, s47, v57
    v_lshlrev_b32 v172, 16, v58
    v_and_b32 v173, s47, v58
    v_lshlrev_b32 v174, 16, v59
    v_and_b32 v175, s47, v59
    v_perm_b32 v160, v52, v48, s38
    v_perm_b32 v161, v52, v48, s39
    v_perm_b32 v162, v53, v49, s38
    v_perm_b32 v163, v53, v49, s39
    v_perm_b32 v164, v54, v50, s38
    v_perm_b32 v165, v54, v50, s39
    v_perm_b32 v166, v55, v51, s38
    v_perm_b32 v167, v55, v51, s39
    s_waitcnt vmcnt(2)
    v_xor_b32 v64, v64, v7
    v_xor_b32 v68, v68, v7
    v_xor_b32 v65, v65, v7
    v_xor_b32 v69, v69, v7
    v_max_f32 v72, v64, v68
    v_or3_b32 v70, v64, v65, v68
    v_or_b32 v70, v70, v69
    v_max_f32_dpp v72, v72, v72 row_ror:8 row_mask:0xf bank_mask:0xf
    v_and_b32 v70, 0xff, v70
    v_mov_b32 v73, v72
    s_nop 1
    v_permlane16_swap_b32 v72, v73
    v_max_f32 v72, v72, v73
    v_mov_b32 v73, v72
    s_nop 1
    v_permlane32_swap_b32 v72, v73
    v_max_f32 v72, v72, v73
    v_sub_f32 v64, v64, v72
    v_sub_f32 v68, v68, v72
    v_exp_f32 v64, v64
    v_exp_f32 v68, v68
    v_mul_f32 v73, v64, v65
    v_fmac_f32 v73, v68, v69
    v_mov_b32 v65, v64
    v_mov_b32 v69, v68
    v_add_f32_dpp v73, v73, v73 row_ror:8 row_mask:0xf bank_mask:0xf
    v_mov_b32 v71, v73
    s_nop 1
    v_permlane16_swap_b32 v73, v71
    v_add_f32 v73, v73, v71
    v_mov_b32 v71, v73
    s_nop 1
    v_permlane32_swap_b32 v73, v71
    v_add_f32 v73, v73, v71
    s_waitcnt vmcnt(0)
    v_xor_b32 v80, v80, v20
    v_xor_b32 v81, v81, v21
    v_xor_b32 v82, v82, v22
    v_xor_b32 v83, v83, v23
    v_xor_b32 v84, v84, v20
    v_xor_b32 v85, v85, v21
    v_xor_b32 v86, v86, v22
    v_xor_b32 v87, v87, v23
    v_or3_b32 v71, v80, v81, v82
    v_or3_b32 v71, v83, v84, v71
    v_or3_b32 v71, v85, v86, v71
    v_or_b32 v71, v87, v71
    v_and_or_b32 v70, v71, s69, v70
    v_cmp_ne_u32 vcc, 0, v70
    s_cbranch_vccz L_h3d
    s_sub_u32 s40, s40, 1
    s_cbranch_scc0 L_h3
L_h3d:
    ds_write_b64 v74, v[72:73]
    v_lshl_or_b32 v88, v80, 16, v14
    v_and_or_b32 v89, v80, s47, v14
    v_lshl_or_b32 v90, v81, 16, v14
    v_and_or_b32 v91, v81, s47, v14
    v_lshl_or_b32 v92, v82, 16, v14
    v_and_or_b32 v93, v82, s47, v14
    v_lshl_or_b32 v94, v83, 16, v14
    v_and_or_b32 v95, v83, s47, v14
    v_lshl_or_b32 v96, v84, 16, v14
    v_and_or_b32 v97, v84, s47, v14
    v_lshl_or_b32 v98, v85, 16, v14
    v_and_or_b32 v99, v85, s47, v14
    v_lshl_or_b32 v100, v86, 16, v14
    v_and_or_b32 v101, v86, s47, v14
    v_lshl_or_b32 v102, v87, 16, v14
    v_and_or_b32 v103, v87, s47, v14
    v_pk_mul_f32 v[88:89], v[64:65], v[88:89]
    v_pk_mul_f32 v[90:91], v[64:65], v[90:91]
    v_pk_mul_f32 v[92:93], v[64:65], v[92:93]
    v_pk_mul_f32 v[94:95], v[64:65], v[94:95]
    v_pk_fma_f32 v[88:89], v[68:69], v[96:97], v[88:89]
    v_pk_fma_f32 v[90:91], v[68:69], v[98:99], v[90:91]
    v_pk_fma_f32 v[92:93], v[68:69], v[100:101], v[92:93]
    v_pk_fma_f32 v[94:95], v[68:69], v[102:103], v[94:95]
    s_nop 0
    v_permlane32_swap_b32 v88, v92
    v_permlane32_swap_b32 v89, v93
    v_permlane32_swap_b32 v90, v94
    v_permlane32_swap_b32 v91, v95
    v_pk_add_f32 v[88:89], v[88:89], v[92:93]
    v_pk_add_f32 v[90:91], v[90:91], v[94:95]
    s_nop 1
    v_permlane16_swap_b32 v88, v90
    v_permlane16_swap_b32 v89, v91
    v_pk_add_f32 v[88:89], v[88:89], v[90:91]
    v_cvt_pk_bf16_f32 v88, v88, v89
    ds_write_b32 v75, v88
    s_cmp_lg_u32 s46, s3
    s_cbranch_scc1 L_nhf
    s_mov_b32 s40, 100000
L_hf_8:
    s_waitcnt vmcnt(0)
    v_xor_b32 v104, v104, v7
    v_xor_b32 v105, v105, v7
    v_xor_b32 v106, v106, v7
    v_xor_b32 v107, v107, v7
    v_or3_b32 v108, v104, v105, v106
    v_or_b32 v108, v107, v108
    v_and_b32 v108, 0xff, v108
    v_cmp_ne_u32 vcc, 0, v108
    s_cbranch_vccz L_hfd_9
    s_sub_u32 s40, s40, 1
    s_cbranch_scc1 L_hfd_9
    buffer_load_dword v104, v10, s[48:51], s45 offen offset:0 sc1
    buffer_load_dword v105, v10, s[48:51], s45 offen offset:256 sc1
    buffer_load_dword v106, v10, s[48:51], s45 offen offset:512 sc1
    buffer_load_dword v107, v10, s[48:51], s45 offen offset:768 sc1
    s_branch L_hf_8
L_hfd_9:
    v_add_f32 v104, v104, v105
    v_add_f32 v105, v106, v107
    s_nop 0
    v_add_f32_dpp v104, v104, v104 quad_perm:[1,0,3,2] row_mask:0xf bank_mask:0xf
    v_add_f32_dpp v105, v105, v105 quad_perm:[1,0,3,2] row_mask:0xf bank_mask:0xf
    s_nop 0
    v_add_f32_dpp v104, v104, v104 quad_perm:[2,3,0,1] row_mask:0xf bank_mask:0xf
    v_add_f32_dpp v105, v105, v105 quad_perm:[2,3,0,1] row_mask:0xf bank_mask:0xf
    s_nop 0
    v_add_f32_dpp v104, v104, v104 row_half_mirror row_mask:0xf bank_mask:0xf
    v_add_f32_dpp v105, v105, v105 row_half_mirror row_mask:0xf bank_mask:0xf
    ds_write_b64 v13, v[104:105]
L_nhf:
    s_waitcnt lgkmcnt(0)
    s_barrier
    ds_read_b64 v[64:65], v78
    ds_read_b128 v[80:83], v76
    ds_read_b64_tr_b16 v[88:89], v77
    ds_read_b64_tr_b16 v[90:91], v77 offset:4096
    ds_read_b128 v[84:87], v76 offset:64
    ds_read_b64_tr_b16 v[92:93], v77 offset:8192
    ds_read_b64_tr_b16 v[94:95], v77 offset:12288
    ds_read_b128 v[68:71], v79
    ds_read_b64 v[124:125], v13
    s_waitcnt lgkmcnt(8)
    v_max_f32_dpp v66, v64, v64 quad_perm:[1,0,3,2] row_mask:0xf bank_mask:0xf
    s_waitcnt lgkmcnt(5)
    v_mfma_f32_16x16x32_bf16 v[96:99], v[80:83], v[88:91], 0
    v_max_f32_dpp v66, v66, v66 quad_perm:[2,3,0,1] row_mask:0xf bank_mask:0xf
    s_waitcnt lgkmcnt(2)
    v_mfma_f32_16x16x32_bf16 v[96:99], v[84:87], v[92:95], v[96:99]
    v_max_f32_dpp v66, v66, v66 row_half_mirror row_mask:0xf bank_mask:0xf
    s_waitcnt lgkmcnt(0)
    v_sub_f32 v64, v64, v66
    v_sub_f32 v68, v68, v66
    v_sub_f32 v70, v70, v66
    v_exp_f32 v64, v64
    v_exp_f32 v68, v68
    v_exp_f32 v70, v70
    v_mul_f32 v64, v64, v65
    v_add_f32 v96, v96, v97
    v_add_f32 v98, v98, v99
    v_add_f32_dpp v64, v64, v64 quad_perm:[1,0,3,2] row_mask:0xf bank_mask:0xf
    v_mul_f32 v96, v96, v68
    v_fmac_f32 v96, v98, v70
    v_add_f32_dpp v64, v64, v64 quad_perm:[2,3,0,1] row_mask:0xf bank_mask:0xf
    v_mov_b32 v97, v96
    s_nop 0
    v_add_f32_dpp v64, v64, v64 row_half_mirror row_mask:0xf bank_mask:0xf
    v_permlane16_swap_b32 v96, v97
    v_rcp_f32 v64, v64
    v_add_f32 v96, v96, v97
    v_mov_b32 v97, v96
    s_nop 1
    v_permlane32_swap_b32 v96, v97
    v_add_f32 v96, v96, v97
    v_mul_f32 v96, v96, v64
    v_and_or_b32 v96, v96, s68, v7
    s_mov_b32 s26, 0x1000
    s_add_u32 s27, s43, 0x1000
    s_mov_b64 exec, 0xffff
    buffer_store_dword v96, v15, s[48:51], s26 offen
    s_mov_b64 exec, -1
    buffer_load_dwordx2 v[104:105], v9, s[48:51], s27 offen sc1
    v_cvt_pk_bf16_f32 v124, v124, v125
    v_and_b32 v125, s47, v124
    v_lshlrev_b32 v124, 16, v124
    v_mul_f32 v100, v124, v124
    v_mov_b32 v101, 0xc0135761
    v_fmac_f32 v101, 0xbdd2d3e8, v100
    v_mul_f32 v100, v101, v124
    v_exp_f32 v100, v100
    s_nop 0
    v_add_f32 v100, 1.0, v100
    v_rcp_f32 v100, v100
    s_nop 0
    v_mul_f32 v124, v124, v100
    v_cvt_pk_bf16_f32 v124, v124, v124
    v_lshlrev_b32 v124, 16, v124
    v_mul_f32 v124, v124, v125
    v_cvt_pk_bf16_f32 v13, v124, v124
    v_lshlrev_b32 v13, 16, v13
    v_mul_f32 v168, v13, v168
    v_mul_f32 v169, v13, v169
    v_mul_f32 v170, v13, v170
    v_mul_f32 v171, v13, v171
    v_mul_f32 v172, v13, v172
    v_mul_f32 v173, v13, v173
    v_mul_f32 v174, v13, v174
    v_mul_f32 v175, v13, v175
    v_permlane32_swap_b32 v168, v172
    v_permlane32_swap_b32 v169, v173
    v_permlane32_swap_b32 v170, v174
    v_permlane32_swap_b32 v171, v175
    v_pk_add_f32 v[168:169], v[168:169], v[172:173]
    v_pk_add_f32 v[170:171], v[170:171], v[174:175]
    s_nop 1
    v_permlane16_swap_b32 v168, v170
    v_permlane16_swap_b32 v169, v171
    v_pk_add_f32 v[168:169], v[168:169], v[170:171]
    s_nop 1
    v_add_f32_dpp v125, v168, v168 row_ror:8 row_mask:0xf bank_mask:0x3
    s_nop 1
    v_add_f32_dpp v125, v169, v169 row_ror:8 row_mask:0xf bank_mask:0xc
    v_and_or_b32 v125, v125, s68, v7
    s_mov_b32 s40, 24
    s_waitcnt vmcnt(0)
    s_branch L_l4w
L_l4:
    buffer_load_dwordx2 v[104:105], v9, s[48:51], s27 offen sc1
    s_waitcnt vmcnt(0)
L_l4w:
    v_xor_b32 v104, v104, v7
    v_xor_b32 v105, v105, v7
    v_or_b32 v68, v104, v105
    v_and_b32 v68, 0xff, v68
    v_cmp_ne_u32 vcc, 0, v68
    s_cbranch_vccz L_l4d
    s_sub_u32 s40, s40, 1
    s_cbranch_scc0 L_l4
    s_mov_b64 exec, 0xffff
    buffer_store_dword v96, v15, s[48:51], 0 offen sc1
    s_mov_b64 exec, -1
    buffer_load_dwordx2 v[104:105], v9, s[48:51], s43 offen sc1
    s_mov_b32 s40, 100000
L_h4_10:
    s_waitcnt vmcnt(0)
    v_xor_b32 v104, v104, v7
    v_xor_b32 v105, v105, v7
    v_or_b32 v68, v104, v105
    v_and_b32 v68, 0xff, v68
    v_cmp_ne_u32 vcc, 0, v68
    s_cbranch_vccz L_h4d_11
    s_sub_u32 s40, s40, 1
    s_cbranch_scc1 L_h4d_11
    buffer_load_dwordx2 v[104:105], v9, s[48:51], s43 offen sc1
    s_branch L_h4_10
L_h4d_11:
L_l4d:
    s_mov_b64 exec, 1
    buffer_atomic_add v12, off, s[48:51], s12 sc1
    s_mov_b64 exec, -1
    v_add_f32_dpp v104, v104, v104 quad_perm:[1,0,3,2] row_mask:0xf bank_mask:0xf
    v_add_f32_dpp v105, v105, v105 quad_perm:[1,0,3,2] row_mask:0xf bank_mask:0xf
    s_nop 0
    v_add_f32_dpp v104, v104, v104 quad_perm:[2,3,0,1] row_mask:0xf bank_mask:0xf
    v_add_f32_dpp v105, v105, v105 quad_perm:[2,3,0,1] row_mask:0xf bank_mask:0xf
    s_nop 0
    v_add_f32_dpp v104, v104, v104 row_half_mirror row_mask:0xf bank_mask:0xf
    v_add_f32_dpp v105, v105, v105 row_half_mirror row_mask:0xf bank_mask:0xf
    v_cvt_pk_bf16_f32 v64, v104, v105
    v_dot2_f32_bf16 v72, v160, v64, 0
    v_dot2_f32_bf16 v73, v161, v64, 0
    v_dot2_f32_bf16 v74, v162, v64, 0
    v_dot2_f32_bf16 v75, v163, v64, 0
    v_dot2_f32_bf16 v76, v164, v64, 0
    v_dot2_f32_bf16 v77, v165, v64, 0
    v_dot2_f32_bf16 v78, v166, v64, 0
    v_dot2_f32_bf16 v79, v167, v64, 0
    v_permlane32_swap_b32 v72, v76
    v_permlane32_swap_b32 v73, v77
    v_permlane32_swap_b32 v74, v78
    v_permlane32_swap_b32 v75, v79
    v_pk_add_f32 v[72:73], v[72:73], v[76:77]
    v_pk_add_f32 v[74:75], v[74:75], v[78:79]
    s_nop 1
    v_permlane16_swap_b32 v72, v74
    v_permlane16_swap_b32 v73, v75
    v_pk_add_f32 v[72:73], v[72:73], v[74:75]
    s_nop 1
    v_add_f32_dpp v124, v72, v72 row_ror:8 row_mask:0xf bank_mask:0x3
    s_nop 1
    v_add_f32_dpp v124, v73, v73 row_ror:8 row_mask:0xf bank_mask:0xc
    v_and_or_b32 v124, v124, s68, v7
    buffer_store_dwordx2 v[124:125], v11, s[48:51], s44 offen sc1
    s_cmp_ge_u32 s36, 24
    s_cbranch_scc1 L_isf
    s_mov_b64 exec, 0xffff
    buffer_store_dword v96, v15, s[48:51], 0 offen sc1
    s_mov_b64 exec, -1
    s_branch L_fin
L_isf:
    s_mov_b64 exec, 1
    v_mov_b32 v126, 0
    buffer_atomic_add v126, off, s[48:51], s11 sc0 sc1
    s_mov_b64 exec, -1
    global_load_ushort v127, v176, s[4:5]
    s_mov_b64 exec, 0xffff
    buffer_store_dword v96, v15, s[48:51], 0 offen sc1
    s_mov_b64 exec, -1
    s_mov_b64 exec, 1
    s_mov_b32 s40, 200
    s_branch L_c5w_14
L_c5_12:

    v_mov_b32 v126, 0
    buffer_atomic_add v126, off, s[48:51], s11 sc0 sc1
    s_sub_u32 s40, s40, 1
    s_cbranch_scc1 L_c5d_13
L_c5w_14:
    s_waitcnt vmcnt(0)
    v_cmp_gt_u32 vcc, 32, v126
    s_cbranch_vccnz L_c5_12
L_c5d_13:
    s_mov_b64 exec, -1
    buffer_load_dwordx4 v[64:67], v1, s[48:51], s8 offen sc1
    buffer_load_dwordx4 v[68:71], v1, s[48:51], s9 offen sc1
    s_mov_b32 s40, 100000
L_h5_15:
    s_waitcnt vmcnt(0)
    v_xor_b32 v64, v64, v7
    v_xor_b32 v65, v65, v7
    v_xor_b32 v66, v66, v7
    v_xor_b32 v67, v67, v7
    v_xor_b32 v68, v68, v7
    v_xor_b32 v69, v69, v7
    v_xor_b32 v70, v70, v7
    v_xor_b32 v71, v71, v7
    v_or3_b32 v80, v64, v65, v66
    v_or3_b32 v80, v67, v68, v80
    v_or3_b32 v80, v69, v70, v80
    v_or_b32 v80, v71, v80
    v_and_b32 v80, 0xff, v80
    v_cmp_ne_u32 vcc, 0, v80
    s_cbranch_vccz L_h5d_16
    s_sub_u32 s40, s40, 1
    s_cbranch_scc1 L_h5d_16
    s_mov_b64 exec, vcc
    buffer_load_dwordx4 v[64:67], v1, s[48:51], s8 offen sc1
    buffer_load_dwordx4 v[68:71], v1, s[48:51], s9 offen sc1
    s_branch L_h5_15
L_h5d_16:
    s_mov_b64 exec, -1
    v_pk_add_f32 v[64:65], v[64:65], v[68:69]
    v_pk_add_f32 v[66:67], v[66:67], v[70:71]
    s_nop 1
    v_permlane32_swap_b32 v64, v66
    v_permlane32_swap_b32 v65, v67
    v_pk_add_f32 v[64:65], v[64:65], v[66:67]
    s_nop 1
    v_permlane16_swap_b32 v64, v65
    v_add_f32 v64, v64, v65
    s_nop 1
    v_add_f32_dpp v64, v64, v64 row_ror:8 row_mask:0xf bank_mask:0xf
    s_nop 1
    v_add_f32_dpp v64, v64, v64 row_ror:4 row_mask:0xf bank_mask:0xf
    ds_write_b32 v177, v64
    s_waitcnt lgkmcnt(0)
    s_barrier
    s_cmp_lg_u32 s3, 0
    s_cbranch_scc1 L_fin
    ds_read_b128 v[72:75], v178 offset:256
    ds_read_b128 v[76:79], v178 offset:272
    ds_read_b128 v[64:67], v178
    ds_read_b128 v[68:71], v178 offset:16
    s_waitcnt lgkmcnt(2)
    v_pk_add_f32 v[72:73], v[72:73], v[74:75]
    v_pk_add_f32 v[76:77], v[76:77], v[78:79]
    v_pk_add_f32 v[72:73], v[72:73], v[76:77]
    v_add_f32 v72, v72, v73
    v_cvt_pk_bf16_f32 v72, v72, v72
    v_lshlrev_b32 v72, 16, v72
    v_mul_f32 v73, 0xbfb8aa3b, v72
    v_exp_f32 v73, v73
    s_waitcnt lgkmcnt(0)
    v_pk_add_f32 v[64:65], v[64:65], v[66:67]
    v_pk_add_f32 v[68:69], v[68:69], v[70:71]
    v_add_f32 v73, 1.0, v73
    v_rcp_f32 v73, v73
    v_pk_add_f32 v[64:65], v[64:65], v[68:69]
    v_add_f32 v64, v64, v65
    v_mul_f32 v72, v72, v73
    v_cvt_pk_bf16_f32 v64, v64, v72
    v_lshlrev_b32 v65, 16, v64
    v_and_b32 v64, s47, v64
    v_mul_f32 v64, v64, v65
    v_cvt_pk_bf16_f32 v64, v64, v64
    v_lshlrev_b32 v64, 16, v64
    v_lshlrev_b32 v12, 16, v127
    v_add_f32 v64, v64, v12
    v_cvt_pk_bf16_f32 v64, v64, v64
    s_mov_b64 exec, 0xff
    global_store_short v176, v64, s[24:25]
    s_cmp_lg_u32 s13, 0
    s_cbranch_scc1 L_fin0
    s_mov_b64 exec, 1
    v_mov_b32 v65, s37
    buffer_store_dword v65, off, s[48:51], 0 sc1
L_fin0:
    s_mov_b64 exec, -1
L_fin:
L_end:
    s_endpgm
.section .rodata,"a"
.p2align 6
.amdhsa_kernel recurrent_scan__compressed_kv_cla__geglu_ffn__decode_kernel
  .amdhsa_next_free_vgpr 256
  .amdhsa_next_free_sgpr 102
  .amdhsa_accum_offset 256
  .amdhsa_group_segment_fixed_size 0
  .amdhsa_kernarg_size 104
  .amdhsa_user_sgpr_count 2
  .amdhsa_user_sgpr_kernarg_segment_ptr 1
  .amdhsa_system_sgpr_workgroup_id_x 1
.end_amdhsa_kernel
```
